```python
import torch

def _softmax(x, axis=-1):
    return torch.softmax(x, dim=axis)

def _gelu(x):
    return torch.nn.functional.gelu(x, approximate='tanh')

def _silu(x):
    return torch.nn.functional.silu(x)

def _sigmoid(x):
    return torch.sigmoid(x)

def _layernorm(x, axis=-1, eps=1e-05):
    m = x.mean(dim=axis, keepdim=True)
    v = x.var(dim=axis, keepdim=True, unbiased=False)
    return (x - m) / torch.sqrt(v + eps)

def _scatter_add(tgt, idx, src, axis=0):
    return tgt.clone().index_add_(axis, idx, src)

def _segment_sum(src, seg, n):
    out = torch.zeros((n,) + src.shape[1:], dtype=src.dtype)
    return out.index_add_(0, seg, src)

def _pad(x, pw):
    flat = tuple((v for pair in reversed(pw) for v in pair))
    return torch.nn.functional.pad(x, flat)
kernel_name = 'parallel_sum__softmax_full_mha__mixer_gmlp__prompt'

def setup_inputs():

    _w = lambda a: (lambda t: t.to(torch.bfloat16) if t.is_floating_point() else t)(torch.as_tensor(a))

    def _A_setup():
        B, S, D = (1, 2048, 512)
        return {'x': _w((lambda *s: torch.randn(*s, dtype=torch.bfloat16) * 0.05)(B, S, D)), 'wqkv': _w((lambda *s: torch.randn(*s, dtype=torch.bfloat16) * 0.2)(D, 3 * D)), 'wo': _w((lambda *s: torch.randn(*s, dtype=torch.bfloat16) * 0.2)(D, D))}
    _A_in = _A_setup()

    def _B_setup():
        B, S, D, F = (1, 2048, 512, 1792)
        Fh = F // 2
        return {'x': _w((lambda *s: torch.randn(*s, dtype=torch.bfloat16) * 0.05)(B, S, D)), 'w_in': _w((lambda *s: torch.randn(*s, dtype=torch.bfloat16) * 0.8)(D, 2 * Fh)), 'w_sp': _w(0.01 * (lambda *s: torch.randn(*s, dtype=torch.bfloat16) * 0.8)(S, S)), 'b_sp': _w(1.0 + 0.01 * (lambda *s: torch.randn(*s, dtype=torch.bfloat16) * 0.2)(S)), 'w_out': _w((lambda *s: torch.randn(*s, dtype=torch.bfloat16) * 0.2)(Fh, D))}
    _B_in = _B_setup()
    return {'A_x': _A_in['x'], 'A_wqkv': _A_in['wqkv'], 'A_wo': _A_in['wo'], 'B_x': _B_in['x'], 'B_w_in': _B_in['w_in'], 'B_w_sp': _B_in['w_sp'], 'B_b_sp': _B_in['b_sp'], 'B_w_out': _B_in['w_out']}

def reference(A_x, A_wqkv, A_wo, B_x, B_w_in, B_w_sp, B_b_sp, B_w_out):

    def _A_ref(x, wqkv, wo):
        B, S, D = x.shape
        H = 32
        Dh = D // H
        qkv = (lambda x, *d: x.permute(*d))((x @ wqkv).reshape(B, S, 3, H, Dh), 2, 0, 3, 1, 4)
        q, k, v = (qkv[0], qkv[1], qkv[2])
        scale = Dh ** (-0.5)
        scores = torch.einsum('bhqd,bhkd->bhqk', q, k) * scale
        p = _softmax(scores, axis=-1)
        o = torch.einsum('bhqk,bhkd->bhqd', p, v)
        return (lambda x, *d: x.permute(*d))(o, 0, 2, 1, 3).reshape(B, S, D) @ wo

    def _B_ref(x, w_in, w_sp, b_sp, w_out):
        B, S, D = x.shape
        F = w_in.shape[-1]
        Fh = F // 2
        z = _gelu(torch.einsum('bsd,df->bsf', x, w_in))
        z1 = z[..., :Fh].clone()
        z2 = _layernorm(z[..., Fh:], axis=-1)
        g = torch.einsum('ts,bsf->btf', w_sp, z2) + b_sp[None, :, None]
        return torch.einsum('bsf,fd->bsd', z1 * g, w_out)
    x = A_x
    xn = _layernorm(x, axis=-1)
    return x + _A_ref(xn, A_wqkv, A_wo) + _B_ref(xn, B_w_in, B_w_sp, B_b_sp, B_w_out)
```

```asm
; @launch grid=(512,1,1) block=(512,1,1) lds=81920
.amdgcn_target "amdgcn-amd-amdhsa--gfx950"
.text
.globl parallel_sum__softmax_full_mha__mixer_gmlp__prompt_kernel
.p2align 8
.type parallel_sum__softmax_full_mha__mixer_gmlp__prompt_kernel,@function
parallel_sum__softmax_full_mha__mixer_gmlp__prompt_kernel:
    s_cmp_ge_u32 s2, 512
    s_cbranch_scc1 M_END
    s_load_dwordx8 s[4:11], s[0:1], 0
    s_load_dwordx8 s[12:19], s[0:1], 32
    s_load_dwordx4 s[20:23], s[0:1], 64
    s_load_dwordx2 s[24:25], s[0:1], 80
    v_and_b32 v1, 63, v0
    v_lshrrev_b32 v2, 6, v0
    s_nop 0
    v_readfirstlane_b32 s44, v2
    s_nop 1
    s_sub_u32 s49, s44, 4
    s_and_b32 s3, s2, 255
    s_cmp_ge_u32 s2, 256
    s_cbranch_scc1 M_B
    s_bfe_u32 s45, s3, 0x20001
    s_lshl_b32 s45, s45, 3
    s_bfe_u32 s54, s3, 0x30003
    s_add_u32 s45, s45, s54
    s_and_b32 s46, s3, 1
    s_lshl_b32 s46, s46, 2
    s_lshr_b32 s54, s3, 6
    s_add_u32 s46, s46, s54
    s_and_b32 s47, s3, 7
    s_lshl_b32 s47, s47, 2
    s_bfe_u32 s54, s3, 0x20003
    s_add_u32 s47, s47, s54
    s_lshr_b32 s48, s3, 5
    s_cmp_ge_u32 s44, 4
    s_cbranch_scc0 M_AC
    s_setprio 3
    v_lshrrev_b32 v2, 3, v1
    v_lshrrev_b32 v60, 4, v1
    v_and_b32 v61, 7, v1
    v_xor_b32 v3, v60, v61
    v_bfe_u32 v60, v1, 2, 1
    v_bfe_u32 v61, v1, 4, 1
    v_xor_b32 v60, v60, v61
    v_and_b32 v61, 3, v1
    v_lshl_add_u32 v4, v60, 2, v61
    s_mul_i32 s26, s49, 2048
    s_mul_i32 s54, s49, 16384
    s_mov_b32 s55, 1024
    v_lshlrev_b32 v60, 4, v3
    v_mad_u32_u24 v60, v2, s55, v60
    v_add_u32 v60, s54, v60
    v_xor_b32 v61, 64, v60
    v_add_u32 v8, 0, v60
    v_add_u32 v9, 7168, v61
    s_mul_i32 s27, s49, 3072
    s_mov_b32 s55, 3072
    v_lshlrev_b32 v60, 4, v4
    v_mad_u32_u24 v60, v2, s55, v60
    s_mul_i32 s54, s49, 3
    s_and_b32 s55, s54, 3
    s_mul_i32 s55, s55, 24576
    s_lshr_b32 s54, s54, 2
    s_mul_i32 s54, s54, 1024
    s_add_u32 s54, s54, s55
    v_add_u32 v12, s54, v60
    s_mul_i32 s54, s49, 3
    s_add_u32 s54, s54, 1
    s_and_b32 s55, s54, 3
    s_mul_i32 s55, s55, 24576
    s_lshr_b32 s54, s54, 2
    s_mul_i32 s54, s54, 1024
    s_add_u32 s54, s54, s55
    v_add_u32 v13, s54, v60
    s_mul_i32 s54, s49, 3
    s_add_u32 s54, s54, 2
    s_and_b32 s55, s54, 3
    s_mul_i32 s55, s55, 24576
    s_lshr_b32 s54, s54, 2
    s_mul_i32 s54, s54, 1024
    s_add_u32 s54, s54, s55
    v_add_u32 v14, s54, v60
    v_mov_b32 v6, 0
    s_lshl_b32 s50, s45, 16
    s_lshl_b32 s51, s46, 7
    s_lshl1_add_u32 s54, s46, s45
    s_and_b32 s54, s54, 7
    s_mov_b32 s98, s50
    s_add_u32 s99, s50, 1024
    s_mov_b32 s100, s51
    s_add_u32 s101, s51, 1572864
    s_mul_i32 s55, s54, 128
    s_add_u32 s50, s50, s55
    s_mul_i32 s55, s54, 196608
    s_add_u32 s51, s51, s55
    s_waitcnt lgkmcnt(0)
    s_mov_b32 s32, s4
    s_mov_b32 s33, s5
    s_mov_b32 s34, 2097152
    s_mov_b32 s35, 0x00020000
    s_mov_b32 s36, s6
    s_mov_b32 s37, s7
    s_mov_b32 s38, 1572864
    s_mov_b32 s39, 0x00020000
    s_add_u32 m0, s26, 0
    s_nop 0
    buffer_load_dwordx4 v8, s[32:35], s50 offen offset:0 lds
    buffer_load_dwordx4 v9, s[32:35], s50 offen offset:1024 lds
    s_add_u32 s50, s50, 128
    s_cmp_eq_u32 s50, s99
    s_cselect_b32 s50, s98, s50
    s_add_u32 m0, s27, 16384
    s_nop 0
    buffer_load_dwordx4 v12, s[36:39], s51 offen offset:0 lds
    s_add_u32 m0, s27, 17408
    s_nop 0
    buffer_load_dwordx4 v13, s[36:39], s51 offen offset:0 lds
    s_add_u32 m0, s27, 18432
    s_nop 0
    buffer_load_dwordx4 v14, s[36:39], s51 offen offset:0 lds
    s_add_u32 s51, s51, 98304
    s_cmp_eq_u32 s51, s101
    s_cselect_b32 s51, s100, s51
    s_add_u32 m0, s27, 28672
    s_nop 0
    buffer_load_dwordx4 v12, s[36:39], s51 offen offset:0 lds
    s_add_u32 m0, s27, 29696
    s_nop 0
    buffer_load_dwordx4 v13, s[36:39], s51 offen offset:0 lds
    s_add_u32 m0, s27, 30720
    s_nop 0
    buffer_load_dwordx4 v14, s[36:39], s51 offen offset:0 lds
    s_add_u32 s51, s51, 98304
    s_cmp_eq_u32 s51, s101
    s_cselect_b32 s51, s100, s51
    s_mov_b32 s28, s24
    s_mov_b32 s29, s25
    s_mov_b32 s30, 33554432
    s_mov_b32 s31, 0x00020000
    s_waitcnt vmcnt(3)
    s_barrier
    s_add_u32 m0, s26, 8192
    s_nop 0
    buffer_load_dwordx4 v8, s[32:35], s50 offen offset:0 lds
    buffer_load_dwordx4 v9, s[32:35], s50 offen offset:1024 lds
    s_add_u32 s50, s50, 128
    s_cmp_eq_u32 s50, s99
    s_cselect_b32 s50, s98, s50
    s_add_u32 m0, s27, 40960
    s_nop 0
    buffer_load_dwordx4 v12, s[36:39], s51 offen offset:0 lds
    s_add_u32 m0, s27, 41984
    s_nop 0
    buffer_load_dwordx4 v13, s[36:39], s51 offen offset:0 lds
    s_add_u32 m0, s27, 43008
    s_nop 0
    buffer_load_dwordx4 v14, s[36:39], s51 offen offset:0 lds
    s_add_u32 s51, s51, 98304
    s_cmp_eq_u32 s51, s101
    s_cselect_b32 s51, s100, s51
    s_add_u32 m0, s27, 53248
    s_nop 0
    buffer_load_dwordx4 v12, s[36:39], s51 offen offset:0 lds
    s_add_u32 m0, s27, 54272
    s_nop 0
    buffer_load_dwordx4 v13, s[36:39], s51 offen offset:0 lds
    s_add_u32 m0, s27, 55296
    s_nop 0
    buffer_load_dwordx4 v14, s[36:39], s51 offen offset:0 lds
    s_add_u32 s51, s51, 98304
    s_cmp_eq_u32 s51, s101
    s_cselect_b32 s51, s100, s51
    s_mov_b32 s52, 0
A1_L_LOOP:
    s_waitcnt vmcnt(8)
    s_barrier
    s_add_u32 m0, s27, 16384
    s_nop 0
    buffer_load_dwordx4 v12, s[36:39], s51 offen offset:0 lds
    s_add_u32 m0, s27, 17408
    s_nop 0
    buffer_load_dwordx4 v13, s[36:39], s51 offen offset:0 lds
    s_add_u32 m0, s27, 18432
    s_nop 0
    buffer_load_dwordx4 v14, s[36:39], s51 offen offset:0 lds
    s_add_u32 s51, s51, 98304
    s_cmp_eq_u32 s51, s101
    s_cselect_b32 s51, s100, s51
    s_waitcnt vmcnt(6)
    s_barrier
    s_add_u32 m0, s26, 0
    s_nop 0
    buffer_load_dwordx4 v8, s[32:35], s50 offen offset:0 lds
    buffer_load_dwordx4 v9, s[32:35], s50 offen offset:1024 lds
    s_add_u32 s50, s50, 128
    s_cmp_eq_u32 s50, s99
    s_cselect_b32 s50, s98, s50
    s_add_u32 m0, s27, 28672
    s_nop 0
    buffer_load_dwordx4 v12, s[36:39], s51 offen offset:0 lds
    s_add_u32 m0, s27, 29696
    s_nop 0
    buffer_load_dwordx4 v13, s[36:39], s51 offen offset:0 lds
    s_add_u32 m0, s27, 30720
    s_nop 0
    buffer_load_dwordx4 v14, s[36:39], s51 offen offset:0 lds
    s_add_u32 s51, s51, 98304
    s_cmp_eq_u32 s51, s101
    s_cselect_b32 s51, s100, s51
    s_waitcnt vmcnt(8)
    s_barrier
    s_add_u32 m0, s27, 40960
    s_nop 0
    buffer_load_dwordx4 v12, s[36:39], s51 offen offset:0 lds
    s_add_u32 m0, s27, 41984
    s_nop 0
    buffer_load_dwordx4 v13, s[36:39], s51 offen offset:0 lds
    s_add_u32 m0, s27, 43008
    s_nop 0
    buffer_load_dwordx4 v14, s[36:39], s51 offen offset:0 lds
    s_add_u32 s51, s51, 98304
    s_cmp_eq_u32 s51, s101
    s_cselect_b32 s51, s100, s51
    s_waitcnt vmcnt(6)
    s_barrier
    s_add_u32 m0, s26, 8192
    s_nop 0
    buffer_load_dwordx4 v8, s[32:35], s50 offen offset:0 lds
    buffer_load_dwordx4 v9, s[32:35], s50 offen offset:1024 lds
    s_add_u32 s50, s50, 128
    s_cmp_eq_u32 s50, s99
    s_cselect_b32 s50, s98, s50
    s_add_u32 m0, s27, 53248
    s_nop 0
    buffer_load_dwordx4 v12, s[36:39], s51 offen offset:0 lds
    s_add_u32 m0, s27, 54272
    s_nop 0
    buffer_load_dwordx4 v13, s[36:39], s51 offen offset:0 lds
    s_add_u32 m0, s27, 55296
    s_nop 0
    buffer_load_dwordx4 v14, s[36:39], s51 offen offset:0 lds
    s_add_u32 s51, s51, 98304
    s_cmp_eq_u32 s51, s101
    s_cselect_b32 s51, s100, s51
    s_add_u32 s52, s52, 1
    s_cmp_lt_u32 s52, 3
    s_cbranch_scc1 A1_L_LOOP
    s_waitcnt vmcnt(8)
    s_barrier
    s_waitcnt vmcnt(3)
    s_barrier
    s_waitcnt vmcnt(0)
    s_barrier
    s_barrier
    s_mov_b32 s40, s22
    s_mov_b32 s41, s23
    s_mov_b32 s42, 256
    s_mov_b32 s43, 0x00020000
    buffer_load_dword v7, v6, s[40:43], 0 offen sc1
    v_mov_b32 v64, 0x3f80
    v_mov_b32 v65, 0
    v_mov_b32 v66, 0
    v_mov_b32 v67, 0
    v_lshlrev_b32 v68, 4, v0
    v_add_u32 v68, 61440, v68
    ds_write_b128 v68, v[64:67]
    ds_write_b128 v68, v[64:67] offset:4096
    ds_write_b128 v68, v[64:67] offset:4608
    s_waitcnt lgkmcnt(0)
    s_barrier
    v_and_b32 v62, 1, v1
    v_lshlrev_b32 v62, 8, v62
    s_lshl_b32 s55, s46, 1
    s_and_b32 s54, s45, 1
    s_add_u32 s54, s54, s55
    s_and_b32 s55, s3, 7
    s_lshl_b32 s55, s55, 9
    s_add_u32 s55, s55, 22020096
    s_waitcnt vmcnt(0)
    s_barrier
    s_cmp_eq_u32 s49, 0
    s_cbranch_scc0 AT_START
    v_cmp_ne_u32 vcc, 1, v7
    s_nop 4
    s_cbranch_vccz AL_ZOK
    s_mov_b32 s62, 0
AL_Z_P:
    buffer_load_dword v7, v6, s[40:43], 0 offen sc1
    s_waitcnt vmcnt(0)
    v_cmp_ne_u32 vcc, 1, v7
    s_add_u32 s62, s62, 1
    s_cmp_gt_u32 s62, 20000
    s_cbranch_scc1 AL_Z_X
    s_cbranch_vccz AL_Z_X
    s_sleep 0
    s_branch AL_Z_P
AL_Z_X:
AL_ZOK:
    s_lshl_b32 s62, s54, 8
    s_add_u32 s62, s62, 22020096
    v_mov_b32 v60, 1
    v_mov_b32 v61, 0
    s_mov_b64 exec, 1
    buffer_atomic_add v60, v61, s[28:31], s62 offen sc1
    s_mov_b64 exec, -1
    s_mov_b32 s62, 0
AL_S1_P:
    buffer_load_dword v60, v62, s[28:31], s55 offen sc1
    s_waitcnt vmcnt(0)
    v_cmp_ne_u32 vcc, 16, v60
    s_add_u32 s62, s62, 1
    s_cmp_gt_u32 s62, 20000
    s_cbranch_scc1 AL_S1_X
    s_cbranch_vccz AL_S1_X
    s_sleep 0
    s_branch AL_S1_P
AL_S1_X:
    s_branch AT_START
M_AC:
    s_setprio 2
    v_and_b32 v88, 31, v1
    v_lshrrev_b32 v89, 5, v1
    v_bfe_u32 v90, v88, 1, 3
    v_xor_b32 v90, v90, v89
    v_lshlrev_b32 v90, 4, v90
    v_lshl_add_u32 v2, v88, 7, v90
    v_bfe_u32 v90, v1, 2, 2
    v_lshl_add_u32 v91, v89, 3, v90
    v_lshlrev_b32 v91, 7, v91
    v_bfe_u32 v92, v1, 3, 1
    v_lshl_add_u32 v91, v92, 6, v91
    v_bfe_u32 v92, v1, 4, 1
    v_lshl_add_u32 v91, v92, 5, v91
    v_and_b32 v92, 1, v1
    v_lshl_add_u32 v91, v92, 4, v91
    v_bfe_u32 v92, v1, 1, 1
    v_lshl_add_u32 v3, v92, 3, v91
    s_lshr_b32 s54, s44, 1
    s_xor_b32 s56, s54, s44
    s_and_b32 s56, s56, 1
    s_lshl_b32 s57, s56, 5
    s_lshl_b32 s56, s56, 11
    s_mul_i32 s54, s54, 4096
    v_add_u32 v4, s54, v2
    v_xor_b32 v4, s57, v4
    v_xor_b32 v5, 32, v4
    v_xor_b32 v6, 64, v4
    v_xor_b32 v7, 96, v4
    s_and_b32 s54, s44, 1
    s_mul_i32 s54, s54, 3
    s_and_b32 s55, s54, 1
    s_lshl_b32 s55, s55, 6
    s_lshr_b32 s54, s54, 1
    s_lshl_b32 s54, s54, 12
    s_add_u32 s54, s54, 16384
    s_add_u32 s54, s54, s56
    v_xor_b32 v8, s55, v3
    v_add_u32 v8, s54, v8
    v_xor_b32 v11, 2048, v8
    s_and_b32 s54, s44, 1
    s_mul_i32 s54, s54, 3
    s_add_u32 s54, s54, 1
    s_and_b32 s55, s54, 1
    s_lshl_b32 s55, s55, 6
    s_lshr_b32 s54, s54, 1
    s_lshl_b32 s54, s54, 12
    s_add_u32 s54, s54, 16384
    s_add_u32 s54, s54, s56
    v_xor_b32 v9, s55, v3
    v_add_u32 v9, s54, v9
    v_xor_b32 v12, 2048, v9
    s_and_b32 s54, s44, 1
    s_mul_i32 s54, s54, 3
    s_add_u32 s54, s54, 2
    s_and_b32 s55, s54, 1
    s_lshl_b32 s55, s55, 6
    s_lshr_b32 s54, s54, 1
    s_lshl_b32 s54, s54, 12
    s_add_u32 s54, s54, 16384
    s_add_u32 s54, s54, s56
    v_xor_b32 v10, s55, v3
    v_add_u32 v10, s54, v10
    v_xor_b32 v13, 2048, v10
    v_mov_b32 v112, 0
    v_mov_b32 v113, 0
    v_mov_b32 v96, 0
    v_mov_b32 v97, 0
    v_mov_b32 v98, 0
    v_mov_b32 v99, 0
    v_mov_b32 v100, 0
    v_mov_b32 v101, 0
    v_mov_b32 v102, 0
    v_mov_b32 v103, 0
    v_mov_b32 v104, 0
    v_mov_b32 v105, 0
    v_mov_b32 v106, 0
    v_mov_b32 v107, 0
    v_bfe_u32 v108, v1, 4, 1
    v_xor_b32 v108, v108, v1
    v_and_b32 v108, 1, v108
    v_add_u32 v108, -1, v108
    v_and_b32 v108, 0x3f803f80, v108
    v_mov_b32 v109, v108
    v_mov_b32 v110, v108
    v_mov_b32 v111, v108
    v_mov_b32 v16, 0
    v_mov_b32 v17, 0
    v_mov_b32 v18, 0
    v_mov_b32 v19, 0
    v_mov_b32 v20, 0
    v_mov_b32 v21, 0
    v_mov_b32 v22, 0
    v_mov_b32 v23, 0
    v_mov_b32 v24, 0
    v_mov_b32 v25, 0
    v_mov_b32 v26, 0
    v_mov_b32 v27, 0
    v_mov_b32 v28, 0
    v_mov_b32 v29, 0
    v_mov_b32 v30, 0
    v_mov_b32 v31, 0
    v_mov_b32 v32, 0
    v_mov_b32 v33, 0
    v_mov_b32 v34, 0
    v_mov_b32 v35, 0
    v_mov_b32 v36, 0
    v_mov_b32 v37, 0
    v_mov_b32 v38, 0
    v_mov_b32 v39, 0
    v_mov_b32 v40, 0
    v_mov_b32 v41, 0
    v_mov_b32 v42, 0
    v_mov_b32 v43, 0
    v_mov_b32 v44, 0
    v_mov_b32 v45, 0
    v_mov_b32 v46, 0
    v_mov_b32 v47, 0
    v_mov_b32 v48, 0
    v_mov_b32 v49, 0
    v_mov_b32 v50, 0
    v_mov_b32 v51, 0
    v_mov_b32 v52, 0
    v_mov_b32 v53, 0
    v_mov_b32 v54, 0
    v_mov_b32 v55, 0
    v_mov_b32 v56, 0
    v_mov_b32 v57, 0
    v_mov_b32 v58, 0
    v_mov_b32 v59, 0
    v_mov_b32 v60, 0
    v_mov_b32 v61, 0
    v_mov_b32 v62, 0
    v_mov_b32 v63, 0
    s_waitcnt lgkmcnt(0)
    s_mov_b32 s28, s24
    s_mov_b32 s29, s25
    s_mov_b32 s30, 33554432
    s_mov_b32 s31, 0x00020000
    s_or_b32 s53, s3, s44
    s_cmp_eq_u32 s53, 0
    v_lshlrev_b32 v80, 8, v1
    v_mov_b32 v81, 0
    v_mov_b32 v82, 1
    s_cbranch_scc0 AC_NOZ
    s_mov_b32 s54, 22020096
    s_mov_b32 s55, 22036480
    buffer_store_dword v81, v80, s[28:31], s54 offen sc1
    buffer_store_dword v81, v80, s[28:31], s55 offen sc1
AC_NOZ:
    s_mov_b32 s40, s22
    s_mov_b32 s41, s23
    s_mov_b32 s42, 256
    s_mov_b32 s43, 0x00020000
    s_barrier
    s_cmp_eq_u32 s53, 0
    s_cbranch_scc0 AC_NOZ2
    s_waitcnt vmcnt(0)
    s_mov_b64 exec, 1
    buffer_store_dword v82, v81, s[40:43], 0 offen sc1
    s_mov_b64 exec, -1
AC_NOZ2:
    ds_read_b128 v[64:67], v4 offset:0
    ds_read_b64_tr_b16 v[68:69], v8 offset:0
    ds_read_b64_tr_b16 v[70:71], v8 offset:512
    ds_read_b64_tr_b16 v[72:73], v9 offset:0
    ds_read_b64_tr_b16 v[74:75], v9 offset:512
    ds_read_b64_tr_b16 v[76:77], v10 offset:0
    ds_read_b64_tr_b16 v[78:79], v10 offset:512
    s_mov_b32 s52, 0
A1_C_LOOP:
    s_waitcnt lgkmcnt(4)
    v_mfma_f32_32x32x16_bf16 v[16:31], v[68:71], v[64:67], v[16:31]
    ds_read_b128 v[80:83], v5 offset:0
    ds_read_b64_tr_b16 v[84:85], v11 offset:0
    ds_read_b64_tr_b16 v[86:87], v11 offset:512
    s_waitcnt lgkmcnt(5)
    v_mfma_f32_32x32x16_bf16 v[32:47], v[72:75], v[64:67], v[32:47]
    ds_read_b64_tr_b16 v[88:89], v12 offset:0
    s_waitcnt lgkmcnt(4)
    v_mfma_f32_32x32x16_bf16 v[48:63], v[76:79], v[64:67], v[48:63]
    ds_read_b64_tr_b16 v[90:91], v12 offset:512
    v_mfma_f32_16x16x32_bf16 v[96:99], v[68:71], v[108:111], v[96:99]
    ds_read_b64_tr_b16 v[92:93], v13 offset:0
    v_mfma_f32_16x16x32_bf16 v[104:107], v[76:79], v[108:111], v[104:107]
    ds_read_b64_tr_b16 v[94:95], v13 offset:512
    s_waitcnt lgkmcnt(4)
    v_mfma_f32_32x32x16_bf16 v[16:31], v[84:87], v[80:83], v[16:31]
    v_lshlrev_b32 v114, 16, v80
    v_and_b32 v115, 0xffff0000, v80
    v_add_f32 v112, v112, v114
    v_fmac_f32 v113, v114, v114
    v_add_f32 v112, v112, v115
    v_fmac_f32 v113, v115, v115
    v_lshlrev_b32 v114, 16, v81
    v_and_b32 v115, 0xffff0000, v81
    v_add_f32 v112, v112, v114
    v_fmac_f32 v113, v114, v114
    v_add_f32 v112, v112, v115
    v_fmac_f32 v113, v115, v115
    s_waitcnt lgkmcnt(2)
    v_mfma_f32_32x32x16_bf16 v[32:47], v[88:91], v[80:83], v[32:47]
    v_lshlrev_b32 v114, 16, v82
    v_and_b32 v115, 0xffff0000, v82
    v_add_f32 v112, v112, v114
    v_fmac_f32 v113, v114, v114
    v_add_f32 v112, v112, v115
    v_fmac_f32 v113, v115, v115
    v_lshlrev_b32 v114, 16, v83
    v_and_b32 v115, 0xffff0000, v83
    v_add_f32 v112, v112, v114
    v_fmac_f32 v113, v114, v114
    v_add_f32 v112, v112, v115
    v_fmac_f32 v113, v115, v115
    s_waitcnt lgkmcnt(0)
    s_barrier
    ds_read_b128 v[64:67], v6 offset:0
    ds_read_b64_tr_b16 v[68:69], v8 offset:12288
    ds_read_b64_tr_b16 v[70:71], v8 offset:12800
    v_mfma_f32_32x32x16_bf16 v[48:63], v[92:95], v[80:83], v[48:63]
    ds_read_b64_tr_b16 v[72:73], v9 offset:12288
    ds_read_b64_tr_b16 v[74:75], v9 offset:12800
    v_mfma_f32_16x16x32_bf16 v[100:103], v[88:91], v[108:111], v[100:103]
    ds_read_b64_tr_b16 v[76:77], v10 offset:12288
    ds_read_b64_tr_b16 v[78:79], v10 offset:12800
    s_waitcnt lgkmcnt(4)
    v_mfma_f32_32x32x16_bf16 v[16:31], v[68:71], v[64:67], v[16:31]
    ds_read_b128 v[80:83], v7 offset:0
    ds_read_b64_tr_b16 v[84:85], v11 offset:12288
    ds_read_b64_tr_b16 v[86:87], v11 offset:12800
    s_waitcnt lgkmcnt(5)
    v_mfma_f32_32x32x16_bf16 v[32:47], v[72:75], v[64:67], v[32:47]
    ds_read_b64_tr_b16 v[88:89], v12 offset:12288
    s_waitcnt lgkmcnt(4)
    v_mfma_f32_32x32x16_bf16 v[48:63], v[76:79], v[64:67], v[48:63]
    ds_read_b64_tr_b16 v[90:91], v12 offset:12800
    v_mfma_f32_16x16x32_bf16 v[96:99], v[68:71], v[108:111], v[96:99]
    ds_read_b64_tr_b16 v[92:93], v13 offset:12288
    v_mfma_f32_16x16x32_bf16 v[104:107], v[76:79], v[108:111], v[104:107]
    ds_read_b64_tr_b16 v[94:95], v13 offset:12800
    s_waitcnt lgkmcnt(4)
    v_mfma_f32_32x32x16_bf16 v[16:31], v[84:87], v[80:83], v[16:31]
    v_lshlrev_b32 v114, 16, v80
    v_and_b32 v115, 0xffff0000, v80
    v_add_f32 v112, v112, v114
    v_fmac_f32 v113, v114, v114
    v_add_f32 v112, v112, v115
    v_fmac_f32 v113, v115, v115
    v_lshlrev_b32 v114, 16, v81
    v_and_b32 v115, 0xffff0000, v81
    v_add_f32 v112, v112, v114
    v_fmac_f32 v113, v114, v114
    v_add_f32 v112, v112, v115
    v_fmac_f32 v113, v115, v115
    s_waitcnt lgkmcnt(2)
    v_mfma_f32_32x32x16_bf16 v[32:47], v[88:91], v[80:83], v[32:47]
    v_lshlrev_b32 v114, 16, v82
    v_and_b32 v115, 0xffff0000, v82
    v_add_f32 v112, v112, v114
    v_fmac_f32 v113, v114, v114
    v_add_f32 v112, v112, v115
    v_fmac_f32 v113, v115, v115
    v_lshlrev_b32 v114, 16, v83
    v_and_b32 v115, 0xffff0000, v83
    v_add_f32 v112, v112, v114
    v_fmac_f32 v113, v114, v114
    v_add_f32 v112, v112, v115
    v_fmac_f32 v113, v115, v115
    s_waitcnt lgkmcnt(0)
    s_barrier
    ds_read_b128 v[64:67], v4 offset:8192
    ds_read_b64_tr_b16 v[68:69], v8 offset:24576
    ds_read_b64_tr_b16 v[70:71], v8 offset:25088
    v_mfma_f32_32x32x16_bf16 v[48:63], v[92:95], v[80:83], v[48:63]
    ds_read_b64_tr_b16 v[72:73], v9 offset:24576
    ds_read_b64_tr_b16 v[74:75], v9 offset:25088
    v_mfma_f32_16x16x32_bf16 v[100:103], v[88:91], v[108:111], v[100:103]
    ds_read_b64_tr_b16 v[76:77], v10 offset:24576
    ds_read_b64_tr_b16 v[78:79], v10 offset:25088
    s_waitcnt lgkmcnt(4)
    v_mfma_f32_32x32x16_bf16 v[16:31], v[68:71], v[64:67], v[16:31]
    ds_read_b128 v[80:83], v5 offset:8192
    ds_read_b64_tr_b16 v[84:85], v11 offset:24576
    ds_read_b64_tr_b16 v[86:87], v11 offset:25088
    s_waitcnt lgkmcnt(5)
    v_mfma_f32_32x32x16_bf16 v[32:47], v[72:75], v[64:67], v[32:47]
    ds_read_b64_tr_b16 v[88:89], v12 offset:24576
    s_waitcnt lgkmcnt(4)
    v_mfma_f32_32x32x16_bf16 v[48:63], v[76:79], v[64:67], v[48:63]
    ds_read_b64_tr_b16 v[90:91], v12 offset:25088
    v_mfma_f32_16x16x32_bf16 v[96:99], v[68:71], v[108:111], v[96:99]
    ds_read_b64_tr_b16 v[92:93], v13 offset:24576
    v_mfma_f32_16x16x32_bf16 v[104:107], v[76:79], v[108:111], v[104:107]
    ds_read_b64_tr_b16 v[94:95], v13 offset:25088
    s_waitcnt lgkmcnt(4)
    v_mfma_f32_32x32x16_bf16 v[16:31], v[84:87], v[80:83], v[16:31]
    v_lshlrev_b32 v114, 16, v80
    v_and_b32 v115, 0xffff0000, v80
    v_add_f32 v112, v112, v114
    v_fmac_f32 v113, v114, v114
    v_add_f32 v112, v112, v115
    v_fmac_f32 v113, v115, v115
    v_lshlrev_b32 v114, 16, v81
    v_and_b32 v115, 0xffff0000, v81
    v_add_f32 v112, v112, v114
    v_fmac_f32 v113, v114, v114
    v_add_f32 v112, v112, v115
    v_fmac_f32 v113, v115, v115
    s_waitcnt lgkmcnt(2)
    v_mfma_f32_32x32x16_bf16 v[32:47], v[88:91], v[80:83], v[32:47]
    v_lshlrev_b32 v114, 16, v82
    v_and_b32 v115, 0xffff0000, v82
    v_add_f32 v112, v112, v114
    v_fmac_f32 v113, v114, v114
    v_add_f32 v112, v112, v115
    v_fmac_f32 v113, v115, v115
    v_lshlrev_b32 v114, 16, v83
    v_and_b32 v115, 0xffff0000, v83
    v_add_f32 v112, v112, v114
    v_fmac_f32 v113, v114, v114
    v_add_f32 v112, v112, v115
    v_fmac_f32 v113, v115, v115
    s_waitcnt lgkmcnt(0)
    s_barrier
    ds_read_b128 v[64:67], v6 offset:8192
    ds_read_b64_tr_b16 v[68:69], v8 offset:36864
    ds_read_b64_tr_b16 v[70:71], v8 offset:37376
    v_mfma_f32_32x32x16_bf16 v[48:63], v[92:95], v[80:83], v[48:63]
    ds_read_b64_tr_b16 v[72:73], v9 offset:36864
    ds_read_b64_tr_b16 v[74:75], v9 offset:37376
    v_mfma_f32_16x16x32_bf16 v[100:103], v[88:91], v[108:111], v[100:103]
    ds_read_b64_tr_b16 v[76:77], v10 offset:36864
    ds_read_b64_tr_b16 v[78:79], v10 offset:37376
    s_waitcnt lgkmcnt(4)
    v_mfma_f32_32x32x16_bf16 v[16:31], v[68:71], v[64:67], v[16:31]
    ds_read_b128 v[80:83], v7 offset:8192
    ds_read_b64_tr_b16 v[84:85], v11 offset:36864
    ds_read_b64_tr_b16 v[86:87], v11 offset:37376
    s_waitcnt lgkmcnt(5)
    v_mfma_f32_32x32x16_bf16 v[32:47], v[72:75], v[64:67], v[32:47]
    ds_read_b64_tr_b16 v[88:89], v12 offset:36864
    s_waitcnt lgkmcnt(4)
    v_mfma_f32_32x32x16_bf16 v[48:63], v[76:79], v[64:67], v[48:63]
    ds_read_b64_tr_b16 v[90:91], v12 offset:37376
    v_mfma_f32_16x16x32_bf16 v[96:99], v[68:71], v[108:111], v[96:99]
    ds_read_b64_tr_b16 v[92:93], v13 offset:36864
    v_mfma_f32_16x16x32_bf16 v[104:107], v[76:79], v[108:111], v[104:107]
    ds_read_b64_tr_b16 v[94:95], v13 offset:37376
    s_waitcnt lgkmcnt(4)
    v_mfma_f32_32x32x16_bf16 v[16:31], v[84:87], v[80:83], v[16:31]
    v_lshlrev_b32 v114, 16, v80
    v_and_b32 v115, 0xffff0000, v80
    v_add_f32 v112, v112, v114
    v_fmac_f32 v113, v114, v114
    v_add_f32 v112, v112, v115
    v_fmac_f32 v113, v115, v115
    v_lshlrev_b32 v114, 16, v81
    v_and_b32 v115, 0xffff0000, v81
    v_add_f32 v112, v112, v114
    v_fmac_f32 v113, v114, v114
    v_add_f32 v112, v112, v115
    v_fmac_f32 v113, v115, v115
    s_waitcnt lgkmcnt(2)
    v_mfma_f32_32x32x16_bf16 v[32:47], v[88:91], v[80:83], v[32:47]
    v_lshlrev_b32 v114, 16, v82
    v_and_b32 v115, 0xffff0000, v82
    v_add_f32 v112, v112, v114
    v_fmac_f32 v113, v114, v114
    v_add_f32 v112, v112, v115
    v_fmac_f32 v113, v115, v115
    v_lshlrev_b32 v114, 16, v83
    v_and_b32 v115, 0xffff0000, v83
    v_add_f32 v112, v112, v114
    v_fmac_f32 v113, v114, v114
    v_add_f32 v112, v112, v115
    v_fmac_f32 v113, v115, v115
    s_waitcnt lgkmcnt(0)
    s_barrier
    ds_read_b128 v[64:67], v4 offset:0
    ds_read_b64_tr_b16 v[68:69], v8 offset:0
    ds_read_b64_tr_b16 v[70:71], v8 offset:512
    v_mfma_f32_32x32x16_bf16 v[48:63], v[92:95], v[80:83], v[48:63]
    ds_read_b64_tr_b16 v[72:73], v9 offset:0
    ds_read_b64_tr_b16 v[74:75], v9 offset:512
    v_mfma_f32_16x16x32_bf16 v[100:103], v[88:91], v[108:111], v[100:103]
    ds_read_b64_tr_b16 v[76:77], v10 offset:0
    ds_read_b64_tr_b16 v[78:79], v10 offset:512
    s_add_u32 s52, s52, 1
    s_cmp_lt_u32 s52, 4
    s_cbranch_scc1 A1_C_LOOP
    s_lshr_b32 s54, s44, 1
    s_and_b32 s55, s44, 1
    s_mul_i32 s56, s54, 1024
    s_add_u32 s56, s56, 74752
    s_lshl_b32 s57, s55, 4
    s_mul_i32 s55, s55, 768
    s_add_u32 s55, s55, 76800
    s_lshl_b32 s54, s54, 7
    s_add_u32 s54, s54, s55
    v_and_b32 v108, 31, v1
    v_lshlrev_b32 v108, 5, v108
    v_add_u32 v108, s56, v108
    v_lshrrev_b32 v110, 5, v1
    v_lshl_add_u32 v110, v110, 3, v108
    v_add_u32 v110, s57, v110
    ds_write_b64 v110, v[112:113] offset:0
    v_and_b32 v109, 1, v1
    v_lshlrev_b32 v109, 6, v109
    v_and_b32 v110, 48, v1
    v_add3_u32 v109, v109, v110, s54
    s_mov_b32 exec_lo, 0x30003
    s_mov_b32 exec_hi, 0x30003
    ds_write_b128 v109, v[96:99] offset:0
    ds_write_b128 v109, v[100:103] offset:256
    ds_write_b128 v109, v[104:107] offset:512
    s_mov_b64 exec, -1
    s_waitcnt lgkmcnt(0)
    v_lshlrev_b32 v109, 2, v1
    v_add_u32 v109, s55, v109
    s_barrier
    ds_read_b128 v[116:119], v108 offset:0
    ds_read_b128 v[120:123], v108 offset:16
    ds_read_b32 v96, v109 offset:0
    ds_read_b32 v97, v109 offset:256
    ds_read_b32 v98, v109 offset:512
    v_mov_b32 v66, 0
    v_mov_b32 v67, 0
    v_mov_b32 v70, 0
    v_mov_b32 v71, 0
    v_mov_b32 v74, 0
    v_mov_b32 v75, 0
    v_mov_b32 v78, 0
    v_mov_b32 v79, 0
    s_waitcnt lgkmcnt(0)
    v_add_f32 v116, v116, v118
    v_cvt_pk_bf16_f32 v99, v96, v96
    v_cvt_pk_bf16_f32 v102, v97, v97
    v_cvt_pk_bf16_f32 v105, v98, v98
    v_add_f32 v120, v120, v122
    v_lshlrev_b32 v99, 16, v99
    v_lshlrev_b32 v102, 16, v102
    v_lshlrev_b32 v105, 16, v105
    v_add_f32 v116, v116, v120
    v_sub_f32 v100, v96, v99
    v_sub_f32 v103, v97, v102
    v_sub_f32 v106, v98, v105
    v_mul_f32 v116, 0x3b000000, v116
    v_cvt_pk_bf16_f32 v68, v99, v100
    v_cvt_pk_bf16_f32 v72, v102, v103
    v_cvt_pk_bf16_f32 v76, v105, v106
    v_cvt_pk_bf16_f32 v64, -v116, -v116
    v_and_b32 v101, 0xffff0000, v68
    v_and_b32 v104, 0xffff0000, v72
    v_and_b32 v107, 0xffff0000, v76
    v_cvt_pk_bf16_f32 v65, -v116, -v116
    v_sub_f32 v100, v100, v101
    v_sub_f32 v103, v103, v104
    v_sub_f32 v106, v106, v107
    v_cvt_pk_bf16_f32 v69, v100, 0
    v_cvt_pk_bf16_f32 v73, v103, 0
    v_cvt_pk_bf16_f32 v77, v106, 0
    v_mfma_f32_32x32x16_bf16 v[16:31], v[68:71], v[64:67], v[16:31]
    v_mfma_f32_32x32x16_bf16 v[32:47], v[72:75], v[64:67], v[32:47]
    v_mfma_f32_32x32x16_bf16 v[48:63], v[76:79], v[64:67], v[48:63]
    v_add_f32 v117, v117, v119
    v_add_f32 v121, v121, v123
    v_add_f32 v117, v117, v121
    v_mul_f32 v117, 0x3b000000, v117
    v_fma_f32 v117, -v116, v116, v117
    v_max_f32 v117, 0, v117
    v_cvt_pk_bf16_f32 v117, v117, v117
    v_lshlrev_b32 v117, 16, v117
    v_add_f32 v117, 0x3727c5ac, v117
    v_cvt_pk_bf16_f32 v117, v117, v117
    v_lshlrev_b32 v117, 16, v117
    v_sqrt_f32 v117, v117
    s_nop 0
    v_cvt_pk_bf16_f32 v117, v117, v117
    v_lshlrev_b32 v117, 16, v117
    v_rcp_f32 v14, v117
    s_lshr_b32 s54, s44, 1
    s_lshl_b32 s54, s54, 5
    s_lshl_b32 s55, s45, 6
    s_add_u32 s54, s54, s55
    v_and_b32 v12, 31, v1
    v_add_u32 v12, s54, v12
    v_lshlrev_b32 v12, 5, v12
    v_lshrrev_b32 v13, 5, v1
    v_lshl_add_u32 v12, v13, 4, v12
    s_and_b32 s55, s44, 1
    s_mul_i32 s55, s55, 3
    s_mov_b32 s56, 0x3eb8aa3b
    s_mov_b32 s57, 0x3eb8aa3b
    v_mul_f32 v16, v16, v14
    v_mul_f32 v17, v17, v14
    v_cvt_pk_bf16_f32 v104, v16, v17
    v_mul_f32 v18, v18, v14
    v_mul_f32 v19, v19, v14
    v_cvt_pk_bf16_f32 v105, v18, v19
    v_mul_f32 v20, v20, v14
    v_mul_f32 v21, v21, v14
    v_cvt_pk_bf16_f32 v106, v20, v21
    v_mul_f32 v22, v22, v14
    v_mul_f32 v23, v23, v14
    v_cvt_pk_bf16_f32 v107, v22, v23
    v_mul_f32 v24, v24, v14
    v_mul_f32 v25, v25, v14
    v_cvt_pk_bf16_f32 v108, v24, v25
    v_mul_f32 v26, v26, v14
    v_mul_f32 v27, v27, v14
    v_cvt_pk_bf16_f32 v109, v26, v27
    v_mul_f32 v28, v28, v14
    v_mul_f32 v29, v29, v14
    v_cvt_pk_bf16_f32 v110, v28, v29
    v_mul_f32 v30, v30, v14
    v_mul_f32 v31, v31, v14
    v_cvt_pk_bf16_f32 v111, v30, v31
    s_lshr_b32 s54, s55, 1
    s_lshl_b32 s54, s54, 3
    s_add_u32 s54, s54, s46
    s_lshl_b32 s54, s54, 1
    s_and_b32 s58, s55, 1
    s_add_u32 s54, s54, s58
    s_lshl_b32 s58, s54, 17
    s_add_u32 s59, s58, 65536
    s_cmp_lt_u32 s54, 16
    s_cbranch_scc0 AC_NQ0
    v_lshlrev_b32 v16, 16, v104
    v_and_b32 v17, 0xffff0000, v104
    v_mul_f32 v16, s56, v16
    v_mul_f32 v17, s56, v17
    v_cvt_pk_bf16_f32 v104, v16, v17
    v_lshlrev_b32 v18, 16, v105
    v_and_b32 v19, 0xffff0000, v105
    v_mul_f32 v18, s56, v18
    v_mul_f32 v19, s56, v19
    v_cvt_pk_bf16_f32 v105, v18, v19
    v_lshlrev_b32 v20, 16, v106
    v_and_b32 v21, 0xffff0000, v106
    v_mul_f32 v20, s56, v20
    v_mul_f32 v21, s56, v21
    v_cvt_pk_bf16_f32 v106, v20, v21
    v_lshlrev_b32 v22, 16, v107
    v_and_b32 v23, 0xffff0000, v107
    v_mul_f32 v22, s56, v22
    v_mul_f32 v23, s56, v23
    v_cvt_pk_bf16_f32 v107, v22, v23
    v_lshlrev_b32 v24, 16, v108
    v_and_b32 v25, 0xffff0000, v108
    v_mul_f32 v24, s56, v24
    v_mul_f32 v25, s56, v25
    v_cvt_pk_bf16_f32 v108, v24, v25
    v_lshlrev_b32 v26, 16, v109
    v_and_b32 v27, 0xffff0000, v109
    v_mul_f32 v26, s56, v26
    v_mul_f32 v27, s56, v27
    v_cvt_pk_bf16_f32 v109, v26, v27
    v_lshlrev_b32 v28, 16, v110
    v_and_b32 v29, 0xffff0000, v110
    v_mul_f32 v28, s56, v28
    v_mul_f32 v29, s56, v29
    v_cvt_pk_bf16_f32 v110, v28, v29
    v_lshlrev_b32 v30, 16, v111
    v_and_b32 v31, 0xffff0000, v111
    v_mul_f32 v30, s56, v30
    v_mul_f32 v31, s56, v31
    v_cvt_pk_bf16_f32 v111, v30, v31
AC_NQ0:
    buffer_store_dwordx4 v[104:107], v12, s[28:31], s58 offen sc1
    buffer_store_dwordx4 v[108:111], v12, s[28:31], s59 offen sc1
    s_add_u32 s55, s55, 1
    v_mul_f32 v32, v32, v14
    v_mul_f32 v33, v33, v14
    v_cvt_pk_bf16_f32 v112, v32, v33
    v_mul_f32 v34, v34, v14
    v_mul_f32 v35, v35, v14
    v_cvt_pk_bf16_f32 v113, v34, v35
    v_mul_f32 v36, v36, v14
    v_mul_f32 v37, v37, v14
    v_cvt_pk_bf16_f32 v114, v36, v37
    v_mul_f32 v38, v38, v14
    v_mul_f32 v39, v39, v14
    v_cvt_pk_bf16_f32 v115, v38, v39
    v_mul_f32 v40, v40, v14
    v_mul_f32 v41, v41, v14
    v_cvt_pk_bf16_f32 v116, v40, v41
    v_mul_f32 v42, v42, v14
    v_mul_f32 v43, v43, v14
    v_cvt_pk_bf16_f32 v117, v42, v43
    v_mul_f32 v44, v44, v14
    v_mul_f32 v45, v45, v14
    v_cvt_pk_bf16_f32 v118, v44, v45
    v_mul_f32 v46, v46, v14
    v_mul_f32 v47, v47, v14
    v_cvt_pk_bf16_f32 v119, v46, v47
    s_lshr_b32 s54, s55, 1
    s_lshl_b32 s54, s54, 3
    s_add_u32 s54, s54, s46
    s_lshl_b32 s54, s54, 1
    s_and_b32 s58, s55, 1
    s_add_u32 s54, s54, s58
    s_lshl_b32 s58, s54, 17
    s_add_u32 s59, s58, 65536
    s_cmp_lt_u32 s54, 16
    s_cbranch_scc0 AC_NQ1
    v_lshlrev_b32 v32, 16, v112
    v_and_b32 v33, 0xffff0000, v112
    v_mul_f32 v32, s56, v32
    v_mul_f32 v33, s56, v33
    v_cvt_pk_bf16_f32 v112, v32, v33
    v_lshlrev_b32 v34, 16, v113
    v_and_b32 v35, 0xffff0000, v113
    v_mul_f32 v34, s56, v34
    v_mul_f32 v35, s56, v35
    v_cvt_pk_bf16_f32 v113, v34, v35
    v_lshlrev_b32 v36, 16, v114
    v_and_b32 v37, 0xffff0000, v114
    v_mul_f32 v36, s56, v36
    v_mul_f32 v37, s56, v37
    v_cvt_pk_bf16_f32 v114, v36, v37
    v_lshlrev_b32 v38, 16, v115
    v_and_b32 v39, 0xffff0000, v115
    v_mul_f32 v38, s56, v38
    v_mul_f32 v39, s56, v39
    v_cvt_pk_bf16_f32 v115, v38, v39
    v_lshlrev_b32 v40, 16, v116
    v_and_b32 v41, 0xffff0000, v116
    v_mul_f32 v40, s56, v40
    v_mul_f32 v41, s56, v41
    v_cvt_pk_bf16_f32 v116, v40, v41
    v_lshlrev_b32 v42, 16, v117
    v_and_b32 v43, 0xffff0000, v117
    v_mul_f32 v42, s56, v42
    v_mul_f32 v43, s56, v43
    v_cvt_pk_bf16_f32 v117, v42, v43
    v_lshlrev_b32 v44, 16, v118
    v_and_b32 v45, 0xffff0000, v118
    v_mul_f32 v44, s56, v44
    v_mul_f32 v45, s56, v45
    v_cvt_pk_bf16_f32 v118, v44, v45
    v_lshlrev_b32 v46, 16, v119
    v_and_b32 v47, 0xffff0000, v119
    v_mul_f32 v46, s56, v46
    v_mul_f32 v47, s56, v47
    v_cvt_pk_bf16_f32 v119, v46, v47
AC_NQ1:
    buffer_store_dwordx4 v[112:115], v12, s[28:31], s58 offen sc1
    buffer_store_dwordx4 v[116:119], v12, s[28:31], s59 offen sc1
    s_add_u32 s55, s55, 1
    v_mul_f32 v48, v48, v14
    v_mul_f32 v49, v49, v14
    v_cvt_pk_bf16_f32 v120, v48, v49
    v_mul_f32 v50, v50, v14
    v_mul_f32 v51, v51, v14
    v_cvt_pk_bf16_f32 v121, v50, v51
    v_mul_f32 v52, v52, v14
    v_mul_f32 v53, v53, v14
    v_cvt_pk_bf16_f32 v122, v52, v53
    v_mul_f32 v54, v54, v14
    v_mul_f32 v55, v55, v14
    v_cvt_pk_bf16_f32 v123, v54, v55
    v_mul_f32 v56, v56, v14
    v_mul_f32 v57, v57, v14
    v_cvt_pk_bf16_f32 v124, v56, v57
    v_mul_f32 v58, v58, v14
    v_mul_f32 v59, v59, v14
    v_cvt_pk_bf16_f32 v125, v58, v59
    v_mul_f32 v60, v60, v14
    v_mul_f32 v61, v61, v14
    v_cvt_pk_bf16_f32 v126, v60, v61
    v_mul_f32 v62, v62, v14
    v_mul_f32 v63, v63, v14
    v_cvt_pk_bf16_f32 v127, v62, v63
    s_lshr_b32 s54, s55, 1
    s_lshl_b32 s54, s54, 3
    s_add_u32 s54, s54, s46
    s_lshl_b32 s54, s54, 1
    s_and_b32 s58, s55, 1
    s_add_u32 s54, s54, s58
    s_lshl_b32 s58, s54, 17
    s_add_u32 s59, s58, 65536
    s_cmp_lt_u32 s54, 16
    s_cbranch_scc0 AC_NQ2
    v_lshlrev_b32 v48, 16, v120
    v_and_b32 v49, 0xffff0000, v120
    v_mul_f32 v48, s56, v48
    v_mul_f32 v49, s56, v49
    v_cvt_pk_bf16_f32 v120, v48, v49
    v_lshlrev_b32 v50, 16, v121
    v_and_b32 v51, 0xffff0000, v121
    v_mul_f32 v50, s56, v50
    v_mul_f32 v51, s56, v51
    v_cvt_pk_bf16_f32 v121, v50, v51
    v_lshlrev_b32 v52, 16, v122
    v_and_b32 v53, 0xffff0000, v122
    v_mul_f32 v52, s56, v52
    v_mul_f32 v53, s56, v53
    v_cvt_pk_bf16_f32 v122, v52, v53
    v_lshlrev_b32 v54, 16, v123
    v_and_b32 v55, 0xffff0000, v123
    v_mul_f32 v54, s56, v54
    v_mul_f32 v55, s56, v55
    v_cvt_pk_bf16_f32 v123, v54, v55
    v_lshlrev_b32 v56, 16, v124
    v_and_b32 v57, 0xffff0000, v124
    v_mul_f32 v56, s56, v56
    v_mul_f32 v57, s56, v57
    v_cvt_pk_bf16_f32 v124, v56, v57
    v_lshlrev_b32 v58, 16, v125
    v_and_b32 v59, 0xffff0000, v125
    v_mul_f32 v58, s56, v58
    v_mul_f32 v59, s56, v59
    v_cvt_pk_bf16_f32 v125, v58, v59
    v_lshlrev_b32 v60, 16, v126
    v_and_b32 v61, 0xffff0000, v126
    v_mul_f32 v60, s56, v60
    v_mul_f32 v61, s56, v61
    v_cvt_pk_bf16_f32 v126, v60, v61
    v_lshlrev_b32 v62, 16, v127
    v_and_b32 v63, 0xffff0000, v127
    v_mul_f32 v62, s56, v62
    v_mul_f32 v63, s56, v63
    v_cvt_pk_bf16_f32 v127, v62, v63
AC_NQ2:
    buffer_store_dwordx4 v[120:123], v12, s[28:31], s58 offen sc1
    buffer_store_dwordx4 v[124:127], v12, s[28:31], s59 offen sc1
    s_add_u32 s55, s55, 1
    s_waitcnt vmcnt(0)
    s_barrier
AT_START:
    s_mov_b32 s53, 0
    v_and_b32 v116, 31, v1
    s_lshl_b32 s54, s44, 5
    v_add_u32 v116, s54, v116
    v_lshlrev_b32 v116, 5, v116
    v_lshrrev_b32 v117, 5, v1
    v_lshl_add_u32 v5, v117, 4, v116
    v_lshrrev_b32 v116, 1, v1
    v_lshlrev_b32 v116, 5, v116
    v_bfe_u32 v117, v1, 4, 1
    v_xor_b32 v117, v117, v1
    v_and_b32 v117, 1, v117
    v_lshl_add_u32 v6, v117, 4, v116
    v_lshlrev_b32 v7, 4, v1
    v_add_u32 v7, 2097152, v7
    s_lshl_b32 s56, s47, 16
    s_lshl_b32 s57, s48, 13
    s_add_u32 s57, s57, s56
    s_mov_b32 s32, s24
    s_mov_b32 s33, s25
    s_mov_b32 s34, 33554432
    s_mov_b32 s35, 0x00020000
    s_barrier
    s_setprio 0
    buffer_load_dwordx4 v[88:91], v5, s[28:31], s57 offen
AT_RESTART:
    s_lshl_b32 s26, s44, 10
    s_add_u32 s50, s56, s26
    s_add_u32 s50, s50, 2097152
    s_mov_b32 s34, 33554432
    s_add_u32 m0, s26, 32768
    s_nop 0
    buffer_load_dwordx4 v6, s[32:35], s50 offen lds
    s_add_u32 m0, s26, 0
    s_nop 0
    buffer_load_dwordx4 v7, s[32:35], s50 offen lds
    s_add_u32 s50, s50, 8192
    s_add_u32 s26, s26, 8192
    s_and_b32 s26, s26, 0x7fff
    s_add_u32 m0, s26, 32768
    s_nop 0
    buffer_load_dwordx4 v6, s[32:35], s50 offen lds
    s_add_u32 m0, s26, 0
    s_nop 0
    buffer_load_dwordx4 v7, s[32:35], s50 offen lds
    s_add_u32 s50, s50, 8192
    s_add_u32 s26, s26, 8192
    s_and_b32 s26, s26, 0x7fff
    s_add_u32 m0, s26, 32768
    s_nop 0
    buffer_load_dwordx4 v6, s[32:35], s50 offen lds
    s_add_u32 m0, s26, 0
    s_nop 0
    buffer_load_dwordx4 v7, s[32:35], s50 offen lds
    s_add_u32 s50, s50, 8192
    s_add_u32 s26, s26, 8192
    s_and_b32 s26, s26, 0x7fff
    v_and_b32 v116, 19, v1
    v_bfe_u32 v117, v1, 2, 1
    v_lshl_add_u32 v116, v117, 3, v116
    v_bfe_u32 v118, v1, 3, 1
    v_lshl_add_u32 v116, v118, 2, v116
    v_lshlrev_b32 v116, 5, v116
    v_lshrrev_b32 v118, 5, v1
    v_xor_b32 v117, v117, v118
    v_lshl_add_u32 v2, v117, 4, v116
    v_bfe_u32 v116, v1, 2, 2
    v_lshl_add_u32 v116, v118, 3, v116
    v_lshlrev_b32 v116, 5, v116
    v_and_b32 v117, 1, v1
    v_lshl_add_u32 v116, v117, 4, v116
    v_bfe_u32 v117, v1, 1, 1
    v_lshl_add_u32 v116, v117, 3, v116
    v_bfe_u32 v117, v1, 4, 1
    v_cmp_eq_u32 vcc, 1, v117
    v_add_u32 v117, 65664, v116
    s_nop 0
    v_cndmask_b32 v3, v116, v117, vcc
    v_mov_b32 v117, 8192
    v_cndmask_b32 v4, v117, 0, vcc
    v_mov_b32 v56, 0
    v_mov_b32 v57, 0
    v_mov_b32 v58, 0
    v_mov_b32 v59, 0
    v_mov_b32 v60, 0
    v_mov_b32 v61, 0
    v_mov_b32 v62, 0
    v_mov_b32 v63, 0
    v_mov_b32 v64, 0
    v_mov_b32 v65, 0
    v_mov_b32 v66, 0
    v_mov_b32 v67, 0
    v_mov_b32 v68, 0
    v_mov_b32 v69, 0
    v_mov_b32 v70, 0
    v_mov_b32 v71, 0
    v_mov_b32 v48, 0
    v_mov_b32 v49, 0
    v_mov_b32 v50, 0
    v_mov_b32 v51, 0
    v_mov_b32 v52, 0
    v_mov_b32 v53, 0
    v_mov_b32 v54, 0
    v_mov_b32 v55, 0
    v_mov_b32 v108, 0
    v_mov_b32 v109, 0
    v_mov_b32 v110, 0
    v_mov_b32 v111, 0
    v_mov_b32 v112, 0
    v_mov_b32 v113, 0
    v_mov_b32 v114, 0
    v_mov_b32 v115, 0
    s_waitcnt vmcnt(4)
    s_barrier
    ds_read_b128 v[92:95], v2 offset:32768
    ds_read_b128 v[96:99], v2 offset:33792
    s_cmp_eq_u32 s53, 1
    s_waitcnt lgkmcnt(0)
    s_cbranch_scc1 AT_HAVE_M
    v_mfma_f32_32x32x16_bf16 v[16:31], v[92:95], v[88:91], 0
    v_mfma_f32_32x32x16_bf16 v[32:47], v[96:99], v[88:91], 0
    s_nop 10
    v_max3_f32 v116, v16, v17, v18
    v_max3_f32 v116, v116, v19, v20
    v_max3_f32 v116, v116, v21, v22
    v_max3_f32 v116, v116, v23, v24
    v_max3_f32 v116, v116, v25, v26
    v_max3_f32 v116, v116, v27, v28
    v_max3_f32 v116, v116, v29, v30
    v_max3_f32 v116, v116, v31, v32
    v_max3_f32 v116, v116, v33, v34
    v_max3_f32 v116, v116, v35, v36
    v_max3_f32 v116, v116, v37, v38
    v_max3_f32 v116, v116, v39, v40
    v_max3_f32 v116, v116, v41, v42
    v_max3_f32 v116, v116, v43, v44
    v_max3_f32 v116, v116, v45, v46
    v_max_f32 v116, v116, v47
    s_mov_b32 s54, 0xc2c80000
AT_FINM:
    v_mov_b32 v118, v116
    s_nop 1
    v_permlane32_swap_b32 v116, v118
    v_max_f32 v116, v116, v118
    v_sub_f32 v72, s54, v116
    v_mov_b32 v73, v72
    v_mov_b32 v74, v72
    v_mov_b32 v75, v72
    v_mov_b32 v76, v72
    v_mov_b32 v77, v72
    v_mov_b32 v78, v72
    v_mov_b32 v79, v72
    v_mov_b32 v80, v72
    v_mov_b32 v81, v72
    v_mov_b32 v82, v72
    v_mov_b32 v83, v72
    v_mov_b32 v84, v72
    v_mov_b32 v85, v72
    v_mov_b32 v86, v72
    v_mov_b32 v87, v72
    s_cmp_eq_u32 s53, 0
    s_cbranch_scc1 AT_HAVE_M
    s_barrier
    s_branch AT_RESTART
AT_HAVE_M:
    v_mfma_f32_32x32x16_bf16 v[16:31], v[92:95], v[88:91], v[72:87]
    s_mov_b32 s52, 0
AT_LOOP:
    s_waitcnt vmcnt(2) lgkmcnt(0)
    s_barrier
    v_mfma_f32_32x32x16_bf16 v[32:47], v[96:99], v[88:91], v[72:87]
    s_nop 7
    v_exp_f32 v16, v16
    ds_read_b64_tr_b16 v[100:101], v3 offset:0
    v_exp_f32 v17, v17
    ds_read_b64_tr_b16 v[102:103], v3 offset:128
    v_exp_f32 v18, v18
    ds_read_b64_tr_b16 v[104:105], v3 offset:512
    v_exp_f32 v19, v19
    ds_read_b64_tr_b16 v[106:107], v3 offset:640
    v_mfma_f32_32x32x16_bf16 v[56:71], v[108:111], v[48:51], v[56:71]
    v_exp_f32 v20, v20
    ds_read_b128 v[92:95], v2 offset:34816
    v_exp_f32 v21, v21
    s_cmp_lt_u32 s52, 5
    v_exp_f32 v22, v22
    s_cselect_b32 s34, 33554432, 0
    v_exp_f32 v23, v23
    s_add_u32 m0, s26, 32768
    v_mfma_f32_32x32x16_bf16 v[56:71], v[112:115], v[52:55], v[56:71]
    v_exp_f32 v24, v24
    buffer_load_dwordx4 v6, s[32:35], s50 offen lds
    v_exp_f32 v25, v25
    s_add_u32 m0, s26, 0
    v_exp_f32 v26, v26
    buffer_load_dwordx4 v7, s[32:35], s50 offen lds
    v_exp_f32 v27, v27
    s_add_u32 s50, s50, 8192
    v_exp_f32 v28, v28
    s_add_u32 s26, s26, 8192
    v_exp_f32 v29, v29
    s_and_b32 s26, s26, 0x7fff
    v_exp_f32 v30, v30
    v_exp_f32 v31, v31
    v_cvt_pk_bf16_f32 v48, v16, v17
    v_cvt_pk_bf16_f32 v49, v18, v19
    v_cvt_pk_bf16_f32 v50, v20, v21
    v_cvt_pk_bf16_f32 v51, v22, v23
    v_cvt_pk_bf16_f32 v52, v24, v25
    v_cvt_pk_bf16_f32 v53, v26, v27
    v_cvt_pk_bf16_f32 v54, v28, v29
    v_cvt_pk_bf16_f32 v55, v30, v31
    s_waitcnt lgkmcnt(0)
    v_mfma_f32_32x32x16_bf16 v[16:31], v[92:95], v[88:91], v[72:87]
    v_exp_f32 v32, v32
    ds_read_b64_tr_b16 v[108:109], v3 offset:1024
    v_exp_f32 v33, v33
    ds_read_b64_tr_b16 v[110:111], v3 offset:1152
    v_exp_f32 v34, v34
    ds_read_b64_tr_b16 v[112:113], v3 offset:1536
    v_exp_f32 v35, v35
    ds_read_b64_tr_b16 v[114:115], v3 offset:1664
    v_mfma_f32_32x32x16_bf16 v[56:71], v[100:103], v[48:51], v[56:71]
    v_exp_f32 v36, v36
    ds_read_b128 v[96:99], v2 offset:35840
    v_exp_f32 v37, v37
    v_exp_f32 v38, v38
    v_exp_f32 v39, v39
    v_mfma_f32_32x32x16_bf16 v[56:71], v[104:107], v[52:55], v[56:71]
    v_exp_f32 v40, v40
    v_exp_f32 v41, v41
    v_exp_f32 v42, v42
    v_exp_f32 v43, v43
    v_exp_f32 v44, v44
    v_exp_f32 v45, v45
    v_exp_f32 v46, v46
    v_exp_f32 v47, v47
    v_cvt_pk_bf16_f32 v48, v32, v33
    v_cvt_pk_bf16_f32 v49, v34, v35
    v_cvt_pk_bf16_f32 v50, v36, v37
    v_cvt_pk_bf16_f32 v51, v38, v39
    v_cvt_pk_bf16_f32 v52, v40, v41
    v_cvt_pk_bf16_f32 v53, v42, v43
    v_cvt_pk_bf16_f32 v54, v44, v45
    v_cvt_pk_bf16_f32 v55, v46, v47
    s_waitcnt lgkmcnt(0)
    v_mfma_f32_32x32x16_bf16 v[32:47], v[96:99], v[88:91], v[72:87]
    v_exp_f32 v16, v16
    ds_read_b64_tr_b16 v[100:101], v3 offset:2048
    v_exp_f32 v17, v17
    ds_read_b64_tr_b16 v[102:103], v3 offset:2176
    v_exp_f32 v18, v18
    ds_read_b64_tr_b16 v[104:105], v3 offset:2560
    v_exp_f32 v19, v19
    ds_read_b64_tr_b16 v[106:107], v3 offset:2688
    v_mfma_f32_32x32x16_bf16 v[56:71], v[108:111], v[48:51], v[56:71]
    v_exp_f32 v20, v20
    ds_read_b128 v[92:95], v2 offset:36864
    v_exp_f32 v21, v21
    v_exp_f32 v22, v22
    v_exp_f32 v23, v23
    v_mfma_f32_32x32x16_bf16 v[56:71], v[112:115], v[52:55], v[56:71]
    v_exp_f32 v24, v24
    v_exp_f32 v25, v25
    v_exp_f32 v26, v26
    v_exp_f32 v27, v27
    v_exp_f32 v28, v28
    v_exp_f32 v29, v29
    v_exp_f32 v30, v30
    v_exp_f32 v31, v31
    v_cvt_pk_bf16_f32 v48, v16, v17
    v_cvt_pk_bf16_f32 v49, v18, v19
    v_cvt_pk_bf16_f32 v50, v20, v21
    v_cvt_pk_bf16_f32 v51, v22, v23
    v_cvt_pk_bf16_f32 v52, v24, v25
    v_cvt_pk_bf16_f32 v53, v26, v27
    v_cvt_pk_bf16_f32 v54, v28, v29
    v_cvt_pk_bf16_f32 v55, v30, v31
    s_waitcnt lgkmcnt(0)
    v_mfma_f32_32x32x16_bf16 v[16:31], v[92:95], v[88:91], v[72:87]
    v_exp_f32 v32, v32
    ds_read_b64_tr_b16 v[108:109], v3 offset:3072
    v_exp_f32 v33, v33
    ds_read_b64_tr_b16 v[110:111], v3 offset:3200
    v_exp_f32 v34, v34
    ds_read_b64_tr_b16 v[112:113], v3 offset:3584
    v_exp_f32 v35, v35
    ds_read_b64_tr_b16 v[114:115], v3 offset:3712
    v_mfma_f32_32x32x16_bf16 v[56:71], v[100:103], v[48:51], v[56:71]
    v_exp_f32 v36, v36
    ds_read_b128 v[96:99], v2 offset:37888
    v_exp_f32 v37, v37
    v_exp_f32 v38, v38
    v_exp_f32 v39, v39
    v_mfma_f32_32x32x16_bf16 v[56:71], v[104:107], v[52:55], v[56:71]
    v_exp_f32 v40, v40
    v_exp_f32 v41, v41
    v_exp_f32 v42, v42
    v_exp_f32 v43, v43
    v_exp_f32 v44, v44
    v_exp_f32 v45, v45
    v_exp_f32 v46, v46
    v_exp_f32 v47, v47
    v_cvt_pk_bf16_f32 v48, v32, v33
    v_cvt_pk_bf16_f32 v49, v34, v35
    v_cvt_pk_bf16_f32 v50, v36, v37
    v_cvt_pk_bf16_f32 v51, v38, v39
    v_cvt_pk_bf16_f32 v52, v40, v41
    v_cvt_pk_bf16_f32 v53, v42, v43
    v_cvt_pk_bf16_f32 v54, v44, v45
    v_cvt_pk_bf16_f32 v55, v46, v47
    s_waitcnt lgkmcnt(0)
    v_mfma_f32_32x32x16_bf16 v[32:47], v[96:99], v[88:91], v[72:87]
    v_exp_f32 v16, v16
    ds_read_b64_tr_b16 v[100:101], v3 offset:4096
    v_exp_f32 v17, v17
    ds_read_b64_tr_b16 v[102:103], v3 offset:4224
    v_exp_f32 v18, v18
    ds_read_b64_tr_b16 v[104:105], v3 offset:4608
    v_exp_f32 v19, v19
    ds_read_b64_tr_b16 v[106:107], v3 offset:4736
    v_mfma_f32_32x32x16_bf16 v[56:71], v[108:111], v[48:51], v[56:71]
    v_exp_f32 v20, v20
    ds_read_b128 v[92:95], v2 offset:38912
    v_exp_f32 v21, v21
    v_exp_f32 v22, v22
    v_exp_f32 v23, v23
    v_mfma_f32_32x32x16_bf16 v[56:71], v[112:115], v[52:55], v[56:71]
    v_exp_f32 v24, v24
    v_exp_f32 v25, v25
    v_exp_f32 v26, v26
    v_exp_f32 v27, v27
    v_exp_f32 v28, v28
    v_exp_f32 v29, v29
    v_exp_f32 v30, v30
    v_exp_f32 v31, v31
    v_cvt_pk_bf16_f32 v48, v16, v17
    v_cvt_pk_bf16_f32 v49, v18, v19
    v_cvt_pk_bf16_f32 v50, v20, v21
    v_cvt_pk_bf16_f32 v51, v22, v23
    v_cvt_pk_bf16_f32 v52, v24, v25
    v_cvt_pk_bf16_f32 v53, v26, v27
    v_cvt_pk_bf16_f32 v54, v28, v29
    v_cvt_pk_bf16_f32 v55, v30, v31
    s_waitcnt lgkmcnt(0)
    v_mfma_f32_32x32x16_bf16 v[16:31], v[92:95], v[88:91], v[72:87]
    v_exp_f32 v32, v32
    ds_read_b64_tr_b16 v[108:109], v3 offset:5120
    v_exp_f32 v33, v33
    ds_read_b64_tr_b16 v[110:111], v3 offset:5248
    v_exp_f32 v34, v34
    ds_read_b64_tr_b16 v[112:113], v3 offset:5632
    v_exp_f32 v35, v35
    ds_read_b64_tr_b16 v[114:115], v3 offset:5760
    v_mfma_f32_32x32x16_bf16 v[56:71], v[100:103], v[48:51], v[56:71]
    v_exp_f32 v36, v36
    ds_read_b128 v[96:99], v2 offset:39936
    v_exp_f32 v37, v37
    v_exp_f32 v38, v38
    v_exp_f32 v39, v39
    v_mfma_f32_32x32x16_bf16 v[56:71], v[104:107], v[52:55], v[56:71]
    v_exp_f32 v40, v40
    v_exp_f32 v41, v41
    v_exp_f32 v42, v42
    v_exp_f32 v43, v43
    v_exp_f32 v44, v44
    v_exp_f32 v45, v45
    v_exp_f32 v46, v46
    v_exp_f32 v47, v47
    v_cvt_pk_bf16_f32 v48, v32, v33
    v_cvt_pk_bf16_f32 v49, v34, v35
    v_cvt_pk_bf16_f32 v50, v36, v37
    v_cvt_pk_bf16_f32 v51, v38, v39
    v_cvt_pk_bf16_f32 v52, v40, v41
    v_cvt_pk_bf16_f32 v53, v42, v43
    v_cvt_pk_bf16_f32 v54, v44, v45
    v_cvt_pk_bf16_f32 v55, v46, v47
    s_waitcnt lgkmcnt(0)
    v_mfma_f32_32x32x16_bf16 v[32:47], v[96:99], v[88:91], v[72:87]
    v_exp_f32 v16, v16
    ds_read_b64_tr_b16 v[100:101], v3 offset:6144
    v_exp_f32 v17, v17
    ds_read_b64_tr_b16 v[102:103], v3 offset:6272
    v_exp_f32 v18, v18
    ds_read_b64_tr_b16 v[104:105], v3 offset:6656
    v_exp_f32 v19, v19
    ds_read_b64_tr_b16 v[106:107], v3 offset:6784
    v_mfma_f32_32x32x16_bf16 v[56:71], v[108:111], v[48:51], v[56:71]
    v_exp_f32 v20, v20
    v_add_u32 v2, 8192, v2
    v_exp_f32 v21, v21
    v_and_b32 v2, 0x7fff, v2
    v_exp_f32 v22, v22
    ds_read_b128 v[92:95], v2 offset:32768
    v_exp_f32 v23, v23
    v_mfma_f32_32x32x16_bf16 v[56:71], v[112:115], v[52:55], v[56:71]
    v_exp_f32 v24, v24
    v_exp_f32 v25, v25
    v_exp_f32 v26, v26
    v_exp_f32 v27, v27
    v_exp_f32 v28, v28
    v_exp_f32 v29, v29
    v_exp_f32 v30, v30
    v_exp_f32 v31, v31
    v_cvt_pk_bf16_f32 v48, v16, v17
    v_cvt_pk_bf16_f32 v49, v18, v19
    v_cvt_pk_bf16_f32 v50, v20, v21
    v_cvt_pk_bf16_f32 v51, v22, v23
    v_cvt_pk_bf16_f32 v52, v24, v25
    v_cvt_pk_bf16_f32 v53, v26, v27
    v_cvt_pk_bf16_f32 v54, v28, v29
    v_cvt_pk_bf16_f32 v55, v30, v31
    s_waitcnt lgkmcnt(0)
    v_mfma_f32_32x32x16_bf16 v[16:31], v[92:95], v[88:91], v[72:87]
    v_exp_f32 v32, v32
    ds_read_b64_tr_b16 v[108:109], v3 offset:7168
    v_exp_f32 v33, v33
    ds_read_b64_tr_b16 v[110:111], v3 offset:7296
    v_exp_f32 v34, v34
    ds_read_b64_tr_b16 v[112:113], v3 offset:7680
    v_exp_f32 v35, v35
    ds_read_b64_tr_b16 v[114:115], v3 offset:7808
    v_mfma_f32_32x32x16_bf16 v[56:71], v[100:103], v[48:51], v[56:71]
    v_exp_f32 v36, v36
    ds_read_b128 v[96:99], v2 offset:33792
    v_exp_f32 v37, v37
    v_add_u32 v3, v4, v3
    v_exp_f32 v38, v38
    v_and_b32 v3, 0x17fff, v3
    v_exp_f32 v39, v39
    s_add_u32 s52, s52, 1
    v_mfma_f32_32x32x16_bf16 v[56:71], v[104:107], v[52:55], v[56:71]
    v_exp_f32 v40, v40
    s_cmp_lt_u32 s52, 8
    v_exp_f32 v41, v41
    v_exp_f32 v42, v42
    v_exp_f32 v43, v43
    v_exp_f32 v44, v44
    v_exp_f32 v45, v45
    v_exp_f32 v46, v46
    v_exp_f32 v47, v47
    v_cvt_pk_bf16_f32 v48, v32, v33
    v_cvt_pk_bf16_f32 v49, v34, v35
    v_cvt_pk_bf16_f32 v50, v36, v37
    v_cvt_pk_bf16_f32 v51, v38, v39
    v_cvt_pk_bf16_f32 v52, v40, v41
    v_cvt_pk_bf16_f32 v53, v42, v43
    v_cvt_pk_bf16_f32 v54, v44, v45
    v_cvt_pk_bf16_f32 v55, v46, v47
    s_cbranch_scc1 AT_LOOP
AT_XIT:
    s_waitcnt lgkmcnt(0)
    v_mfma_f32_32x32x16_bf16 v[56:71], v[108:111], v[48:51], v[56:71]
    v_mfma_f32_32x32x16_bf16 v[56:71], v[112:115], v[52:55], v[56:71]
    s_nop 11
    v_rcp_f32 v120, v64
    s_add_u32 s61, s57, 14680064
    v_mul_f32 v16, v56, v120
    v_mul_f32 v17, v57, v120
    v_cvt_pk_bf16_f32 v48, v16, v17
    v_mul_f32 v18, v58, v120
    v_mul_f32 v19, v59, v120
    v_cvt_pk_bf16_f32 v49, v18, v19
    v_mul_f32 v20, v60, v120
    v_mul_f32 v21, v61, v120
    v_cvt_pk_bf16_f32 v50, v20, v21
    v_mul_f32 v22, v62, v120
    v_mul_f32 v23, v63, v120
    v_cvt_pk_bf16_f32 v51, v22, v23
    buffer_store_dwordx4 v[48:51], v5, s[28:31], s61 offen sc1
    s_cmp_eq_u32 s53, 1
    s_cbranch_scc1 AT_FIN
    s_mov_b32 s60, 0x76800000
    v_cmp_nlt_f32 vcc, v64, s60
    v_add_f32 v118, abs(v56), abs(v57)
    v_add_f32 v118, v118, abs(v58)
    v_add_f32 v118, v118, abs(v59)
    v_add_f32 v118, v118, abs(v60)
    v_add_f32 v118, v118, abs(v61)
    v_add_f32 v118, v118, abs(v62)
    v_add_f32 v118, v118, abs(v63)
    s_mov_b32 s60, 0x203
    v_cmp_class_f32 s[58:59], v118, s60
    s_nop 1
    s_or_b64 vcc, vcc, s[58:59]
    s_cmp_lg_u64 vcc, 0
    s_cselect_b32 s54, 1, 0
    v_mov_b32 v116, s54
    s_lshl_b32 s55, s44, 2
    s_add_u32 s55, s55, 74240
    v_mov_b32 v117, s55
    ds_write_b32 v117, v116
    v_and_b32 v117, 7, v1
    v_lshlrev_b32 v117, 2, v117
    v_add_u32 v117, 74240, v117
    s_waitcnt vmcnt(0) lgkmcnt(0)
    s_barrier
    ds_read_b32 v116, v117
    s_waitcnt lgkmcnt(0)
    v_cmp_ne_u32 vcc, 0, v116
    s_nop 4
    s_cbranch_vccz AT_SIG
    s_mov_b32 s53, 1
    v_and_b32 v120, 31, v1
    v_lshlrev_b32 v120, 5, v120
    v_lshrrev_b32 v121, 5, v1
    v_lshl_add_u32 v120, v121, 4, v120
    s_add_u32 s54, s56, 2097152
    s_mov_b32 s55, 0
    v_mov_b32 v116, 0xff800000
AT_MAXLOOP:
    buffer_load_dwordx4 v[92:95], v120, s[28:31], s54 offen
    s_waitcnt vmcnt(0)
    v_mfma_f32_32x32x16_bf16 v[16:31], v[92:95], v[88:91], 0
    s_nop 11
    v_max3_f32 v116, v116, v16, v17
    v_max3_f32 v116, v116, v18, v19
    v_max3_f32 v116, v116, v20, v21
    v_max3_f32 v116, v116, v22, v23
    v_max3_f32 v116, v116, v24, v25
    v_max3_f32 v116, v116, v26, v27
    v_max3_f32 v116, v116, v28, v29
    v_max3_f32 v116, v116, v30, v31
    s_add_u32 s54, s54, 1024
    s_add_u32 s55, s55, 1
    s_cmp_lt_u32 s55, 64
    s_cbranch_scc1 AT_MAXLOOP
    s_mov_b32 s54, 0
    s_branch AT_FINM
AT_FIN:
    s_waitcnt vmcnt(0)
    s_barrier
AT_SIG:
    s_lshl_b32 s54, s48, 1
    s_lshr_b32 s55, s47, 4
    s_add_u32 s54, s54, s55
    s_add_u32 s54, s54, 80
    s_cmp_eq_u32 s44, 0
    s_cbranch_scc0 AT_END
    s_lshl_b32 s62, s54, 8
    s_add_u32 s62, s62, 22020096
    v_mov_b32 v116, 1
    v_mov_b32 v117, 0
    s_mov_b64 exec, 1
    buffer_atomic_add v116, v117, s[28:31], s62 offen sc1
    s_mov_b64 exec, -1
AT_END:
    s_endpgm
M_B:
    s_bfe_u32 s45, s3, 0x20001
    s_lshl_b32 s45, s45, 2
    s_bfe_u32 s54, s3, 0x20003
    s_add_u32 s45, s45, s54
    s_and_b32 s46, s3, 1
    s_mul_i32 s46, s46, 7
    s_lshr_b32 s48, s3, 5
    s_add_u32 s46, s46, s48
    s_and_b32 s47, s3, 7
    s_lshl_b32 s47, s47, 2
    s_add_u32 s47, s47, s54
    s_cmp_ge_u32 s44, 4
    s_cbranch_scc0 M_BC
    s_setprio 3
    v_lshrrev_b32 v2, 3, v1
    v_lshrrev_b32 v60, 4, v1
    v_and_b32 v61, 7, v1
    v_xor_b32 v3, v60, v61
    v_bfe_u32 v60, v1, 2, 1
    v_bfe_u32 v61, v1, 4, 1
    v_xor_b32 v60, v60, v61
    v_and_b32 v61, 3, v1
    v_lshl_add_u32 v4, v60, 2, v61
    v_and_b32 v5, 1, v1
    v_lshlrev_b32 v5, 8, v5
    v_lshlrev_b32 v16, 4, v1
    v_mov_b32 v6, 0
    v_mov_b32 v7, 0
    s_cmp_lt_u32 s3, 224
    s_cbranch_scc1 BL_Z
    s_waitcnt lgkmcnt(0)
    s_mov_b32 s28, s24
    s_mov_b32 s29, s25
    s_mov_b32 s30, 33554432
    s_mov_b32 s31, 0x00020000
    s_mov_b32 s40, s22
    s_mov_b32 s41, s23
    s_mov_b32 s42, 256
    s_mov_b32 s43, 0x00020000
    s_branch BL_H
BL_Z:
    s_mul_i32 s26, s49, 4096
    s_mul_i32 s54, s49, 32768
    s_mov_b32 s55, 1024
    v_lshlrev_b32 v60, 4, v3
    v_mad_u32_u24 v60, v2, s55, v60
    v_add_u32 v60, s54, v60
    v_xor_b32 v61, 64, v60
    v_add_u32 v8, 0, v60
    v_add_u32 v9, 7168, v61
    v_add_u32 v10, 14336, v60
    v_add_u32 v11, 21504, v61
    s_mul_i32 s27, s49, 2048
    s_mov_b32 s55, 3584
    v_lshlrev_b32 v60, 4, v4
    v_mad_u32_u24 v60, v2, s55, v60
    s_mul_i32 s54, s49, 2
    s_and_b32 s55, s54, 3
    s_mul_i32 s55, s55, 28672
    s_lshr_b32 s54, s54, 2
    s_mul_i32 s54, s54, 1792
    s_add_u32 s54, s54, s55
    v_add_u32 v12, s54, v60
    s_mul_i32 s54, s49, 2
    s_add_u32 s54, s54, 1
    s_and_b32 s55, s54, 3
    s_mul_i32 s55, s55, 28672
    s_lshr_b32 s54, s54, 2
    s_mul_i32 s54, s54, 1792
    s_add_u32 s54, s54, s55
    s_sub_u32 s54, s54, 1024
    v_add_u32 v13, s54, v60
    s_lshl_b32 s50, s45, 17
    s_lshl_b32 s51, s46, 7
    s_lshl1_add_u32 s54, s45, s48
    s_and_b32 s54, s54, 7
    s_mov_b32 s98, s50
    s_add_u32 s99, s50, 1024
    s_mov_b32 s100, s51
    s_add_u32 s101, s51, 1835008
    s_mul_i32 s55, s54, 128
    s_add_u32 s50, s50, s55
    s_mul_i32 s55, s54, 229376
    s_add_u32 s51, s51, s55
    s_waitcnt lgkmcnt(0)
    s_mov_b32 s32, s4
    s_mov_b32 s33, s5
    s_mov_b32 s34, 2097152
    s_mov_b32 s35, 0x00020000
    s_mov_b32 s36, s12
    s_mov_b32 s37, s13
    s_mov_b32 s38, 1835008
    s_mov_b32 s39, 0x00020000
    s_add_u32 m0, s26, 0
    s_nop 0
    buffer_load_dwordx4 v8, s[32:35], s50 offen offset:0 lds
    buffer_load_dwordx4 v9, s[32:35], s50 offen offset:1024 lds
    buffer_load_dwordx4 v10, s[32:35], s50 offen offset:2048 lds
    buffer_load_dwordx4 v11, s[32:35], s50 offen offset:3072 lds
    s_add_u32 s50, s50, 128
    s_cmp_eq_u32 s50, s99
    s_cselect_b32 s50, s98, s50
    s_add_u32 m0, s27, 49152
    s_nop 0
    buffer_load_dwordx4 v12, s[36:39], s51 offen offset:0 lds
    buffer_load_dwordx4 v13, s[36:39], s51 offen offset:1024 lds
    s_add_u32 s51, s51, 114688
    s_cmp_eq_u32 s51, s101
    s_cselect_b32 s51, s100, s51
    s_add_u32 m0, s27, 57344
    s_nop 0
    buffer_load_dwordx4 v12, s[36:39], s51 offen offset:0 lds
    buffer_load_dwordx4 v13, s[36:39], s51 offen offset:1024 lds
    s_add_u32 s51, s51, 114688
    s_cmp_eq_u32 s51, s101
    s_cselect_b32 s51, s100, s51
    s_mov_b32 s28, s24
    s_mov_b32 s29, s25
    s_mov_b32 s30, 33554432
    s_mov_b32 s31, 0x00020000
    s_waitcnt vmcnt(2)
    s_barrier
    s_add_u32 m0, s26, 16384
    s_nop 0
    buffer_load_dwordx4 v8, s[32:35], s50 offen offset:0 lds
    buffer_load_dwordx4 v9, s[32:35], s50 offen offset:1024 lds
    buffer_load_dwordx4 v10, s[32:35], s50 offen offset:2048 lds
    buffer_load_dwordx4 v11, s[32:35], s50 offen offset:3072 lds
    s_add_u32 s50, s50, 128
    s_cmp_eq_u32 s50, s99
    s_cselect_b32 s50, s98, s50
    s_add_u32 m0, s27, 65536
    s_nop 0
    buffer_load_dwordx4 v12, s[36:39], s51 offen offset:0 lds
    buffer_load_dwordx4 v13, s[36:39], s51 offen offset:1024 lds
    s_add_u32 s51, s51, 114688
    s_cmp_eq_u32 s51, s101
    s_cselect_b32 s51, s100, s51
    s_add_u32 m0, s27, 73728
    s_nop 0
    buffer_load_dwordx4 v12, s[36:39], s51 offen offset:0 lds
    buffer_load_dwordx4 v13, s[36:39], s51 offen offset:1024 lds
    s_add_u32 s51, s51, 114688
    s_cmp_eq_u32 s51, s101
    s_cselect_b32 s51, s100, s51
    s_add_u32 m0, s26, 32768
    s_nop 0
    buffer_load_dwordx4 v8, s[32:35], s50 offen offset:0 lds
    buffer_load_dwordx4 v9, s[32:35], s50 offen offset:1024 lds
    buffer_load_dwordx4 v10, s[32:35], s50 offen offset:2048 lds
    buffer_load_dwordx4 v11, s[32:35], s50 offen offset:3072 lds
    s_add_u32 s50, s50, 128
    s_cmp_eq_u32 s50, s99
    s_cselect_b32 s50, s98, s50
    s_waitcnt vmcnt(12)
    s_barrier
    s_add_u32 m0, s27, 49152
    s_nop 0
    buffer_load_dwordx4 v12, s[36:39], s51 offen offset:0 lds
    buffer_load_dwordx4 v13, s[36:39], s51 offen offset:1024 lds
    s_add_u32 s51, s51, 114688
    s_cmp_eq_u32 s51, s101
    s_cselect_b32 s51, s100, s51
    s_waitcnt vmcnt(8)
    s_barrier
    s_add_u32 m0, s26, 0
    s_nop 0
    buffer_load_dwordx4 v8, s[32:35], s50 offen offset:0 lds
    buffer_load_dwordx4 v9, s[32:35], s50 offen offset:1024 lds
    buffer_load_dwordx4 v10, s[32:35], s50 offen offset:2048 lds
    buffer_load_dwordx4 v11, s[32:35], s50 offen offset:3072 lds
    s_add_u32 s50, s50, 128
    s_cmp_eq_u32 s50, s99
    s_cselect_b32 s50, s98, s50
    s_add_u32 m0, s27, 57344
    s_nop 0
    buffer_load_dwordx4 v12, s[36:39], s51 offen offset:0 lds
    buffer_load_dwordx4 v13, s[36:39], s51 offen offset:1024 lds
    s_add_u32 s51, s51, 114688
    s_cmp_eq_u32 s51, s101
    s_cselect_b32 s51, s100, s51
    s_waitcnt vmcnt(12)
    s_barrier
    s_add_u32 m0, s27, 65536
    s_nop 0
    buffer_load_dwordx4 v12, s[36:39], s51 offen offset:0 lds
    buffer_load_dwordx4 v13, s[36:39], s51 offen offset:1024 lds
    s_add_u32 s51, s51, 114688
    s_cmp_eq_u32 s51, s101
    s_cselect_b32 s51, s100, s51
    s_waitcnt vmcnt(8)
    s_barrier
    s_add_u32 m0, s26, 16384
    s_nop 0
    buffer_load_dwordx4 v8, s[32:35], s50 offen offset:0 lds
    buffer_load_dwordx4 v9, s[32:35], s50 offen offset:1024 lds
    buffer_load_dwordx4 v10, s[32:35], s50 offen offset:2048 lds
    buffer_load_dwordx4 v11, s[32:35], s50 offen offset:3072 lds
    s_add_u32 s50, s50, 128
    s_cmp_eq_u32 s50, s99
    s_cselect_b32 s50, s98, s50
    s_add_u32 m0, s27, 73728
    s_nop 0
    buffer_load_dwordx4 v12, s[36:39], s51 offen offset:0 lds
    buffer_load_dwordx4 v13, s[36:39], s51 offen offset:1024 lds
    s_add_u32 s51, s51, 114688
    s_cmp_eq_u32 s51, s101
    s_cselect_b32 s51, s100, s51
    s_waitcnt vmcnt(8)
    s_barrier
    s_add_u32 m0, s27, 49152
    s_nop 0
    buffer_load_dwordx4 v12, s[36:39], s51 offen offset:0 lds
    buffer_load_dwordx4 v13, s[36:39], s51 offen offset:1024 lds
    s_add_u32 s51, s51, 114688
    s_cmp_eq_u32 s51, s101
    s_cselect_b32 s51, s100, s51
    s_waitcnt vmcnt(8)
    s_barrier
    s_add_u32 m0, s26, 32768
    s_nop 0
    buffer_load_dwordx4 v8, s[32:35], s50 offen offset:0 lds
    buffer_load_dwordx4 v9, s[32:35], s50 offen offset:1024 lds
    buffer_load_dwordx4 v10, s[32:35], s50 offen offset:2048 lds
    buffer_load_dwordx4 v11, s[32:35], s50 offen offset:3072 lds
    s_add_u32 s50, s50, 128
    s_cmp_eq_u32 s50, s99
    s_cselect_b32 s50, s98, s50
    s_add_u32 m0, s27, 57344
    s_nop 0
    buffer_load_dwordx4 v12, s[36:39], s51 offen offset:0 lds
    buffer_load_dwordx4 v13, s[36:39], s51 offen offset:1024 lds
    s_add_u32 s51, s51, 114688
    s_cmp_eq_u32 s51, s101
    s_cselect_b32 s51, s100, s51
    s_waitcnt vmcnt(8)
    s_barrier
    s_add_u32 m0, s27, 65536
    s_nop 0
    buffer_load_dwordx4 v12, s[36:39], s51 offen offset:0 lds
    buffer_load_dwordx4 v13, s[36:39], s51 offen offset:1024 lds
    s_add_u32 s51, s51, 114688
    s_cmp_eq_u32 s51, s101
    s_cselect_b32 s51, s100, s51
    s_waitcnt vmcnt(8)
    s_barrier
    s_add_u32 m0, s26, 0
    s_nop 0
    buffer_load_dwordx4 v8, s[32:35], s50 offen offset:0 lds
    buffer_load_dwordx4 v9, s[32:35], s50 offen offset:1024 lds
    buffer_load_dwordx4 v10, s[32:35], s50 offen offset:2048 lds
    buffer_load_dwordx4 v11, s[32:35], s50 offen offset:3072 lds
    s_add_u32 s50, s50, 128
    s_cmp_eq_u32 s50, s99
    s_cselect_b32 s50, s98, s50
    s_add_u32 m0, s27, 73728
    s_nop 0
    buffer_load_dwordx4 v12, s[36:39], s51 offen offset:0 lds
    buffer_load_dwordx4 v13, s[36:39], s51 offen offset:1024 lds
    s_add_u32 s51, s51, 114688
    s_cmp_eq_u32 s51, s101
    s_cselect_b32 s51, s100, s51
    s_waitcnt vmcnt(8)
    s_barrier
    s_add_u32 m0, s27, 49152
    s_nop 0
    buffer_load_dwordx4 v12, s[36:39], s51 offen offset:0 lds
    buffer_load_dwordx4 v13, s[36:39], s51 offen offset:1024 lds
    s_add_u32 s51, s51, 114688
    s_cmp_eq_u32 s51, s101
    s_cselect_b32 s51, s100, s51
    s_waitcnt vmcnt(8)
    s_barrier
    s_add_u32 m0, s26, 16384
    s_nop 0
    buffer_load_dwordx4 v8, s[32:35], s50 offen offset:0 lds
    buffer_load_dwordx4 v9, s[32:35], s50 offen offset:1024 lds
    buffer_load_dwordx4 v10, s[32:35], s50 offen offset:2048 lds
    buffer_load_dwordx4 v11, s[32:35], s50 offen offset:3072 lds
    s_add_u32 s50, s50, 128
    s_cmp_eq_u32 s50, s99
    s_cselect_b32 s50, s98, s50
    s_add_u32 m0, s27, 57344
    s_nop 0
    buffer_load_dwordx4 v12, s[36:39], s51 offen offset:0 lds
    buffer_load_dwordx4 v13, s[36:39], s51 offen offset:1024 lds
    s_add_u32 s51, s51, 114688
    s_cmp_eq_u32 s51, s101
    s_cselect_b32 s51, s100, s51
    s_waitcnt vmcnt(8)
    s_barrier
    s_add_u32 m0, s27, 65536
    s_nop 0
    buffer_load_dwordx4 v12, s[36:39], s51 offen offset:0 lds
    buffer_load_dwordx4 v13, s[36:39], s51 offen offset:1024 lds
    s_add_u32 s51, s51, 114688
    s_cmp_eq_u32 s51, s101
    s_cselect_b32 s51, s100, s51
    s_waitcnt vmcnt(8)
    s_barrier
    s_add_u32 m0, s27, 73728
    s_nop 0
    buffer_load_dwordx4 v12, s[36:39], s51 offen offset:0 lds
    buffer_load_dwordx4 v13, s[36:39], s51 offen offset:1024 lds
    s_add_u32 s51, s51, 114688
    s_cmp_eq_u32 s51, s101
    s_cselect_b32 s51, s100, s51
    s_waitcnt vmcnt(4)
    s_barrier
    s_waitcnt vmcnt(2)
    s_barrier
    s_waitcnt vmcnt(0)
    s_barrier
    s_barrier
    s_mov_b32 s40, s22
    s_mov_b32 s41, s23
    s_mov_b32 s42, 256
    s_mov_b32 s43, 0x00020000
    buffer_load_dword v7, v6, s[40:43], 0 offen sc1
    s_mul_i32 s26, s49, 2048
    s_mul_i32 s54, s49, 65536
    s_mov_b32 s55, 4096
    v_lshlrev_b32 v60, 4, v3
    v_mad_u32_u24 v60, v2, s55, v60
    v_add_u32 v60, s54, v60
    v_xor_b32 v61, 64, v60
    v_add_u32 v8, 0, v60
    v_add_u32 v9, 31744, v61
    s_mul_i32 s27, s49, 2304
    s_mul_i32 s54, s49, 131072
    v_lshlrev_b32 v60, 4, v1
    v_add_u32 v12, s54, v60
    v_add_u32 v13, 64384, v12
    s_mov_b32 s32, s14
    s_mov_b32 s33, s15
    s_mov_b32 s34, 8388608
    s_mov_b32 s35, 0x00020000
    s_lshl_b32 s50, s47, 18
    s_lshl_b32 s51, s48, 19
    s_add_u32 s51, s51, 10485760
    s_mul_i32 s54, s48, 1
    s_mul_i32 s55, s47, 2
    s_add_u32 s54, s54, s55
    s_and_b32 s54, s54, 7
    s_mov_b32 s98, s50
    s_mov_b32 s100, s51
    s_mov_b32 s99, 0
    s_mov_b32 s101, 0
    s_mov_b32 s63, s54
    s_mul_i32 s55, s54, 128
    s_add_u32 s50, s50, s55
    s_mul_i32 s55, s54, 2048
    s_add_u32 s51, s51, s55
    s_cmp_eq_u32 s49, 0
    s_cbranch_scc1 BL_MLN
    s_add_u32 m0, s26, 0
    s_nop 0
    buffer_load_dwordx4 v8, s[32:35], s50 offen offset:0 lds
    buffer_load_dwordx4 v9, s[32:35], s50 offen offset:1024 lds
    s_add_u32 s99, s99, 1
    s_add_u32 s50, s63, s99
    s_and_b32 s50, s50, 7
    s_andn2_b32 s53, s99, 7
    s_or_b32 s50, s50, s53
    s_mul_i32 s50, s50, 128
    s_add_u32 s50, s50, s98
    s_add_u32 m0, s26, 8192
    s_nop 0
    buffer_load_dwordx4 v8, s[32:35], s50 offen offset:0 lds
    buffer_load_dwordx4 v9, s[32:35], s50 offen offset:1024 lds
    s_add_u32 s99, s99, 1
    s_add_u32 s50, s63, s99
    s_and_b32 s50, s50, 7
    s_andn2_b32 s53, s99, 7
    s_or_b32 s50, s50, s53
    s_mul_i32 s50, s50, 128
    s_add_u32 s50, s50, s98
    s_add_u32 m0, s26, 16384
    s_nop 0
    buffer_load_dwordx4 v8, s[32:35], s50 offen offset:0 lds
    buffer_load_dwordx4 v9, s[32:35], s50 offen offset:1024 lds
    s_add_u32 s99, s99, 1
    s_add_u32 s50, s63, s99
    s_and_b32 s50, s50, 7
    s_andn2_b32 s53, s99, 7
    s_or_b32 s50, s50, s53
    s_mul_i32 s50, s50, 128
    s_add_u32 s50, s50, s98
    s_barrier
    s_barrier
    s_barrier
    s_barrier
    s_branch BL_G3
BL_MLN:
    s_barrier
    v_add_u32 v60, 32768, v16
    s_mul_i32 s54, s45, 14336
    s_add_u32 s54, s54, 21037056
    s_lshl_b32 s55, s46, 10
    s_add_u32 s55, s55, s54
    s_add_u32 s56, s45, 16
    s_lshl_b32 s57, s56, 8
    s_add_u32 s57, s57, 22020096
    s_add_u32 s58, s54, 4096
    s_add_u32 s59, s54, 8192
    s_add_u32 s60, s54, 12288
    v_mov_b32 v62, 1
    s_waitcnt vmcnt(0)
    v_cmp_ne_u32 vcc, 1, v7
    s_nop 4
    s_cbranch_vccz BLA_ZOK
    s_mov_b32 s62, 0
BLA_Z_P:
    buffer_load_dword v7, v6, s[40:43], 0 offen sc1
    s_waitcnt vmcnt(0)
    v_cmp_ne_u32 vcc, 1, v7
    s_add_u32 s62, s62, 1
    s_cmp_gt_u32 s62, 20000
    s_cbranch_scc1 BLA_Z_X
    s_cbranch_vccz BLA_Z_X
    s_sleep 0
    s_branch BLA_Z_P
BLA_Z_X:
BLA_ZOK:
    s_mov_b64 exec, 1
    buffer_atomic_add v62, v6, s[28:31], s57 offen sc0 sc1
    s_mov_b64 exec, -1
    s_barrier
    ds_read_b128 v[64:67], v60
    ds_read_b128 v[68:71], v60 offset:1024
    ds_read_b128 v[72:75], v60 offset:2048
    ds_read_b128 v[76:79], v60 offset:3072
    s_waitcnt vmcnt(0) lgkmcnt(0)
    v_add_f32 v64, v64, v68
    v_add_f32 v65, v65, v69
    v_add_f32 v66, v66, v70
    v_add_f32 v67, v67, v71
    v_add_f32 v72, v72, v76
    v_add_f32 v73, v73, v77
    v_add_f32 v74, v74, v78
    v_add_f32 v75, v75, v79
    v_add_f32 v64, v64, v72
    v_add_f32 v65, v65, v73
    v_add_f32 v66, v66, v74
    v_add_f32 v67, v67, v75
    v_or_b32 v64, 1, v64
    v_or_b32 v65, 1, v65
    v_or_b32 v66, 1, v66
    v_or_b32 v67, 1, v67
    buffer_store_dwordx4 v[64:67], v16, s[28:31], s55 offen sc1
    v_readfirstlane_b32 s61, v62
    s_nop 1
    s_cmp_eq_u32 s61, 13
    s_cbranch_scc1 BL_S2_X
    s_mov_b32 s62, 0
BL_S2_P:
    buffer_load_dword v61, v6, s[28:31], s57 offen sc1
    s_waitcnt vmcnt(0)
    v_cmp_ne_u32 vcc, 14, v61
    s_add_u32 s62, s62, 1
    s_cmp_gt_u32 s62, 20000
    s_cbranch_scc1 BL_S2_X
    s_cbranch_vccz BL_S2_X
    s_sleep 0
    s_branch BL_S2_P
BL_S2_X:
    s_mov_b32 s62, 0
BL_LNP:
    buffer_load_dwordx4 v[64:67], v16, s[28:31], s54 offen offset:0 sc1
    buffer_load_dwordx4 v[68:71], v16, s[28:31], s54 offen offset:1024 sc1
    buffer_load_dwordx4 v[72:75], v16, s[28:31], s54 offen offset:2048 sc1
    buffer_load_dwordx4 v[76:79], v16, s[28:31], s54 offen offset:3072 sc1
    buffer_load_dwordx4 v[80:83], v16, s[28:31], s58 offen offset:0 sc1
    buffer_load_dwordx4 v[84:87], v16, s[28:31], s58 offen offset:1024 sc1
    buffer_load_dwordx4 v[88:91], v16, s[28:31], s58 offen offset:2048 sc1
    buffer_load_dwordx4 v[92:95], v16, s[28:31], s58 offen offset:3072 sc1
    buffer_load_dwordx4 v[96:99], v16, s[28:31], s59 offen offset:0 sc1
    buffer_load_dwordx4 v[100:103], v16, s[28:31], s59 offen offset:1024 sc1
    buffer_load_dwordx4 v[104:107], v16, s[28:31], s59 offen offset:2048 sc1
    buffer_load_dwordx4 v[108:111], v16, s[28:31], s59 offen offset:3072 sc1
    buffer_load_dwordx4 v[112:115], v16, s[28:31], s60 offen offset:0 sc1
    buffer_load_dwordx4 v[116:119], v16, s[28:31], s60 offen offset:1024 sc1
    s_waitcnt vmcnt(0)
    v_min_u32 v61, v64, v65
    v_min_u32 v62, v92, v93
    v_min3_u32 v61, v61, v66, v67
    v_min3_u32 v62, v62, v94, v95
    v_min3_u32 v61, v61, v68, v69
    v_min3_u32 v62, v62, v96, v97
    v_min3_u32 v61, v61, v70, v71
    v_min3_u32 v62, v62, v98, v99
    v_min3_u32 v61, v61, v72, v73
    v_min3_u32 v62, v62, v100, v101
    v_min3_u32 v61, v61, v74, v75
    v_min3_u32 v62, v62, v102, v103
    v_min3_u32 v61, v61, v76, v77
    v_min3_u32 v62, v62, v104, v105
    v_min3_u32 v61, v61, v78, v79
    v_min3_u32 v62, v62, v106, v107
    v_min3_u32 v61, v61, v80, v81
    v_min3_u32 v62, v62, v108, v109
    v_min3_u32 v61, v61, v82, v83
    v_min3_u32 v62, v62, v110, v111
    v_min3_u32 v61, v61, v84, v85
    v_min3_u32 v62, v62, v112, v113
    v_min3_u32 v61, v61, v86, v87
    v_min3_u32 v62, v62, v114, v115
    v_min3_u32 v61, v61, v88, v89
    v_min3_u32 v62, v62, v116, v117
    v_min3_u32 v61, v61, v90, v91
    v_min3_u32 v62, v62, v118, v119
    v_min_u32 v61, v61, v62
    v_cmp_eq_u32 vcc, 0, v61
    s_add_u32 s62, s62, 1
    s_cmp_gt_u32 s62, 20000
    s_cbranch_scc1 BL_LNX
    s_cbranch_vccz BL_LNX
    s_sleep 2
    s_branch BL_LNP
BL_LNX:
    v_add_f32 v64, v64, v68
    v_add_f32 v65, v65, v69
    v_add_f32 v66, v66, v70
    v_add_f32 v67, v67, v71
    v_add_f32 v72, v72, v76
    v_add_f32 v73, v73, v77
    v_add_f32 v74, v74, v78
    v_add_f32 v75, v75, v79
    v_add_f32 v80, v80, v84
    v_add_f32 v81, v81, v85
    v_add_f32 v82, v82, v86
    v_add_f32 v83, v83, v87
    v_add_f32 v88, v88, v92
    v_add_f32 v89, v89, v93
    v_add_f32 v90, v90, v94
    v_add_f32 v91, v91, v95
    v_add_f32 v96, v96, v100
    v_add_f32 v97, v97, v101
    v_add_f32 v98, v98, v102
    v_add_f32 v99, v99, v103
    v_add_f32 v104, v104, v108
    v_add_f32 v105, v105, v109
    v_add_f32 v106, v106, v110
    v_add_f32 v107, v107, v111
    v_add_f32 v112, v112, v116
    v_add_f32 v113, v113, v117
    v_add_f32 v114, v114, v118
    v_add_f32 v115, v115, v119
    v_add_f32 v64, v64, v72
    v_add_f32 v65, v65, v73
    v_add_f32 v66, v66, v74
    v_add_f32 v67, v67, v75
    v_add_f32 v80, v80, v88
    v_add_f32 v81, v81, v89
    v_add_f32 v82, v82, v90
    v_add_f32 v83, v83, v91
    v_add_f32 v96, v96, v104
    v_add_f32 v97, v97, v105
    v_add_f32 v98, v98, v106
    v_add_f32 v99, v99, v107
    v_add_f32 v64, v64, v80
    v_add_f32 v65, v65, v81
    v_add_f32 v66, v66, v82
    v_add_f32 v67, v67, v83
    v_add_f32 v96, v96, v112
    v_add_f32 v97, v97, v113
    v_add_f32 v98, v98, v114
    v_add_f32 v99, v99, v115
    v_add_f32 v64, v64, v96
    v_add_f32 v65, v65, v97
    v_add_f32 v66, v66, v98
    v_add_f32 v67, v67, v99
    v_mul_f32 v64, 0x3a924925, v64
    v_mul_f32 v66, 0x3a924925, v66
    v_mul_f32 v65, 0x3a924925, v65
    v_mul_f32 v67, 0x3a924925, v67
    v_fma_f32 v65, -v64, v64, v65
    v_fma_f32 v67, -v66, v66, v67
    v_max_f32 v65, 0, v65
    v_max_f32 v67, 0, v67
    v_cvt_pk_bf16_f32 v65, v65, v65
    v_cvt_pk_bf16_f32 v67, v67, v67
    v_lshlrev_b32 v65, 16, v65
    v_lshlrev_b32 v67, 16, v67
    v_add_f32 v65, 0x3727c5ac, v65
    v_add_f32 v67, 0x3727c5ac, v67
    v_cvt_pk_bf16_f32 v65, v65, v65
    v_cvt_pk_bf16_f32 v67, v67, v67
    v_lshlrev_b32 v65, 16, v65
    v_lshlrev_b32 v67, 16, v67
    v_sqrt_f32 v65, v65
    v_sqrt_f32 v67, v67
    v_cvt_pk_bf16_f32 v65, v65, v65
    v_cvt_pk_bf16_f32 v67, v67, v67
    v_lshlrev_b32 v65, 16, v65
    v_lshlrev_b32 v67, 16, v67
    v_rcp_f32 v65, v65
    v_rcp_f32 v67, v67
    v_cvt_pk_bf16_f32 v64, v64, v64
    v_cvt_pk_bf16_f32 v66, v66, v66
    v_lshlrev_b32 v64, 16, v64
    v_lshlrev_b32 v66, 16, v66
    ds_write_b128 v60, v[64:67] offset:4096
    s_waitcnt lgkmcnt(0)
    s_barrier
    s_add_u32 s54, s46, 32
    s_lshl_b32 s55, s48, 9
    s_add_u32 s55, s55, 22028288
    s_barrier
    s_lshl_b32 s62, s54, 8
    s_add_u32 s62, s62, 22020096
    v_mov_b32 v60, 1
    v_mov_b32 v61, 0
    s_mov_b64 exec, 1
    buffer_atomic_add v60, v61, s[28:31], s62 offen sc1
    s_mov_b64 exec, -1
    s_add_u32 m0, s26, 0
    s_nop 0
    buffer_load_dwordx4 v8, s[32:35], s50 offen offset:0 lds
    buffer_load_dwordx4 v9, s[32:35], s50 offen offset:1024 lds
    s_add_u32 s99, s99, 1
    s_add_u32 s50, s63, s99
    s_and_b32 s50, s50, 7
    s_andn2_b32 s53, s99, 7
    s_or_b32 s50, s50, s53
    s_mul_i32 s50, s50, 128
    s_add_u32 s50, s50, s98
    s_add_u32 m0, s26, 8192
    s_nop 0
    buffer_load_dwordx4 v8, s[32:35], s50 offen offset:0 lds
    buffer_load_dwordx4 v9, s[32:35], s50 offen offset:1024 lds
    s_add_u32 s99, s99, 1
    s_add_u32 s50, s63, s99
    s_and_b32 s50, s50, 7
    s_andn2_b32 s53, s99, 7
    s_or_b32 s50, s50, s53
    s_mul_i32 s50, s50, 128
    s_add_u32 s50, s50, s98
    s_add_u32 m0, s26, 16384
    s_nop 0
    buffer_load_dwordx4 v8, s[32:35], s50 offen offset:0 lds
    buffer_load_dwordx4 v9, s[32:35], s50 offen offset:1024 lds
    s_add_u32 s99, s99, 1
    s_add_u32 s50, s63, s99
    s_and_b32 s50, s50, 7
    s_andn2_b32 s53, s99, 7
    s_or_b32 s50, s50, s53
    s_mul_i32 s50, s50, 128
    s_add_u32 s50, s50, s98
    s_mov_b32 s62, 0
BL_S3_P:
    buffer_load_dword v60, v5, s[28:31], s55 offen sc1
    s_waitcnt vmcnt(0)
    v_cmp_ne_u32 vcc, 16, v60
    s_add_u32 s62, s62, 1
    s_cmp_gt_u32 s62, 20000
    s_cbranch_scc1 BL_S3_X
    s_cbranch_vccz BL_S3_X
    s_sleep 0
    s_branch BL_S3_P
BL_S3_X:
BL_G3:
    s_barrier
    s_add_u32 m0, s27, 24576
    s_nop 0
    buffer_load_dwordx4 v12, s[28:31], s51 offen offset:0 lds
    buffer_load_dwordx4 v13, s[28:31], s51 offen offset:1152 lds
    s_add_u32 s101, s101, 1
    s_lshl1_add_u32 s51, s63, s101
    s_and_b32 s51, s51, 15
    s_andn2_b32 s53, s101, 15
    s_or_b32 s51, s51, s53
    s_mul_i32 s51, s51, 1024
    s_add_u32 s51, s51, s100
    s_add_u32 m0, s27, 33792
    s_nop 0
    buffer_load_dwordx4 v12, s[28:31], s51 offen offset:0 lds
    buffer_load_dwordx4 v13, s[28:31], s51 offen offset:1152 lds
    s_add_u32 s101, s101, 1
    s_lshl1_add_u32 s51, s63, s101
    s_and_b32 s51, s51, 15
    s_andn2_b32 s53, s101, 15
    s_or_b32 s51, s51, s53
    s_mul_i32 s51, s51, 1024
    s_add_u32 s51, s51, s100
    s_add_u32 m0, s27, 43008
    s_nop 0
    buffer_load_dwordx4 v12, s[28:31], s51 offen offset:0 lds
    buffer_load_dwordx4 v13, s[28:31], s51 offen offset:1152 lds
    s_add_u32 s101, s101, 1
    s_lshl1_add_u32 s51, s63, s101
    s_and_b32 s51, s51, 15
    s_andn2_b32 s53, s101, 15
    s_or_b32 s51, s51, s53
    s_mul_i32 s51, s51, 1024
    s_add_u32 s51, s51, s100
    s_add_u32 m0, s27, 52224
    s_nop 0
    buffer_load_dwordx4 v12, s[28:31], s51 offen offset:0 lds
    buffer_load_dwordx4 v13, s[28:31], s51 offen offset:1152 lds
    s_add_u32 s101, s101, 1
    s_lshl1_add_u32 s51, s63, s101
    s_and_b32 s51, s51, 15
    s_andn2_b32 s53, s101, 15
    s_or_b32 s51, s51, s53
    s_mul_i32 s51, s51, 1024
    s_add_u32 s51, s51, s100
    s_add_u32 m0, s27, 61440
    s_nop 0
    buffer_load_dwordx4 v12, s[28:31], s51 offen offset:0 lds
    buffer_load_dwordx4 v13, s[28:31], s51 offen offset:1152 lds
    s_add_u32 s101, s101, 1
    s_lshl1_add_u32 s51, s63, s101
    s_and_b32 s51, s51, 15
    s_andn2_b32 s53, s101, 15
    s_or_b32 s51, s51, s53
    s_mul_i32 s51, s51, 1024
    s_add_u32 s51, s51, s100
    s_add_u32 m0, s27, 70656
    s_nop 0
    buffer_load_dwordx4 v12, s[28:31], s51 offen offset:0 lds
    buffer_load_dwordx4 v13, s[28:31], s51 offen offset:1152 lds
    s_add_u32 s101, s101, 1
    s_lshl1_add_u32 s51, s63, s101
    s_and_b32 s51, s51, 15
    s_andn2_b32 s53, s101, 15
    s_or_b32 s51, s51, s53
    s_mul_i32 s51, s51, 1024
    s_add_u32 s51, s51, s100
    s_waitcnt vmcnt(8)
    s_barrier
    s_mov_b32 s52, 0
B2_L_LOOP:
    s_waitcnt vmcnt(4)
    s_barrier
    s_add_u32 m0, s26, 0
    s_nop 0
    buffer_load_dwordx4 v8, s[32:35], s50 offen offset:0 lds
    buffer_load_dwordx4 v9, s[32:35], s50 offen offset:1024 lds
    s_add_u32 s99, s99, 1
    s_add_u32 s50, s63, s99
    s_and_b32 s50, s50, 7
    s_andn2_b32 s53, s99, 7
    s_or_b32 s50, s50, s53
    s_mul_i32 s50, s50, 128
    s_add_u32 s50, s50, s98
    s_add_u32 m0, s27, 24576
    s_nop 0
    buffer_load_dwordx4 v12, s[28:31], s51 offen offset:0 lds
    buffer_load_dwordx4 v13, s[28:31], s51 offen offset:1152 lds
    s_add_u32 s101, s101, 1
    s_lshl1_add_u32 s51, s63, s101
    s_and_b32 s51, s51, 15
    s_andn2_b32 s53, s101, 15
    s_or_b32 s51, s51, s53
    s_mul_i32 s51, s51, 1024
    s_add_u32 s51, s51, s100
    s_add_u32 m0, s27, 33792
    s_nop 0
    buffer_load_dwordx4 v12, s[28:31], s51 offen offset:0 lds
    buffer_load_dwordx4 v13, s[28:31], s51 offen offset:1152 lds
    s_add_u32 s101, s101, 1
    s_lshl1_add_u32 s51, s63, s101
    s_and_b32 s51, s51, 15
    s_andn2_b32 s53, s101, 15
    s_or_b32 s51, s51, s53
    s_mul_i32 s51, s51, 1024
    s_add_u32 s51, s51, s100
    s_waitcnt vmcnt(6)
    s_barrier
    s_add_u32 m0, s26, 8192
    s_nop 0
    buffer_load_dwordx4 v8, s[32:35], s50 offen offset:0 lds
    buffer_load_dwordx4 v9, s[32:35], s50 offen offset:1024 lds
    s_add_u32 s99, s99, 1
    s_add_u32 s50, s63, s99
    s_and_b32 s50, s50, 7
    s_andn2_b32 s53, s99, 7
    s_or_b32 s50, s50, s53
    s_mul_i32 s50, s50, 128
    s_add_u32 s50, s50, s98
    s_add_u32 m0, s27, 43008
    s_nop 0
    buffer_load_dwordx4 v12, s[28:31], s51 offen offset:0 lds
    buffer_load_dwordx4 v13, s[28:31], s51 offen offset:1152 lds
    s_add_u32 s101, s101, 1
    s_lshl1_add_u32 s51, s63, s101
    s_and_b32 s51, s51, 15
    s_andn2_b32 s53, s101, 15
    s_or_b32 s51, s51, s53
    s_mul_i32 s51, s51, 1024
    s_add_u32 s51, s51, s100
    s_add_u32 m0, s27, 52224
    s_nop 0
    buffer_load_dwordx4 v12, s[28:31], s51 offen offset:0 lds
    buffer_load_dwordx4 v13, s[28:31], s51 offen offset:1152 lds
    s_add_u32 s101, s101, 1
    s_lshl1_add_u32 s51, s63, s101
    s_and_b32 s51, s51, 15
    s_andn2_b32 s53, s101, 15
    s_or_b32 s51, s51, s53
    s_mul_i32 s51, s51, 1024
    s_add_u32 s51, s51, s100
    s_add_u32 s52, s52, 1
    s_cmp_lt_u32 s52, 10
    s_cbranch_scc0 B2_L_DONE
    s_waitcnt vmcnt(6)
    s_barrier
    s_add_u32 m0, s26, 16384
    s_nop 0
    buffer_load_dwordx4 v8, s[32:35], s50 offen offset:0 lds
    buffer_load_dwordx4 v9, s[32:35], s50 offen offset:1024 lds
    s_add_u32 s99, s99, 1
    s_add_u32 s50, s63, s99
    s_and_b32 s50, s50, 7
    s_andn2_b32 s53, s99, 7
    s_or_b32 s50, s50, s53
    s_mul_i32 s50, s50, 128
    s_add_u32 s50, s50, s98
    s_add_u32 m0, s27, 61440
    s_nop 0
    buffer_load_dwordx4 v12, s[28:31], s51 offen offset:0 lds
    buffer_load_dwordx4 v13, s[28:31], s51 offen offset:1152 lds
    s_add_u32 s101, s101, 1
    s_lshl1_add_u32 s51, s63, s101
    s_and_b32 s51, s51, 15
    s_andn2_b32 s53, s101, 15
    s_or_b32 s51, s51, s53
    s_mul_i32 s51, s51, 1024
    s_add_u32 s51, s51, s100
    s_add_u32 m0, s27, 70656
    s_nop 0
    buffer_load_dwordx4 v12, s[28:31], s51 offen offset:0 lds
    buffer_load_dwordx4 v13, s[28:31], s51 offen offset:1152 lds
    s_add_u32 s101, s101, 1
    s_lshl1_add_u32 s51, s63, s101
    s_and_b32 s51, s51, 15
    s_andn2_b32 s53, s101, 15
    s_or_b32 s51, s51, s53
    s_mul_i32 s51, s51, 1024
    s_add_u32 s51, s51, s100
    s_branch B2_L_LOOP
B2_L_DONE:
    s_waitcnt vmcnt(6)
    s_barrier
    s_waitcnt vmcnt(0)
    s_barrier
    s_barrier
BL_H:
    s_mul_i32 s26, s49, 2048
    s_lshl_b32 s54, s49, 16
    v_bfe_u32 v60, v1, 4, 1
    v_xor_b32 v60, v60, v1
    v_lshlrev_b32 v60, 4, v60
    v_add_u32 v8, s54, v60
    s_mul_i32 s27, s49, 1024
    s_mov_b32 s55, 1024
    v_lshlrev_b32 v60, 4, v4
    v_mad_u32_u24 v60, v2, s55, v60
    s_mul_i32 s54, s49, 1
    s_and_b32 s55, s54, 3
    s_mul_i32 s55, s55, 8192
    s_lshr_b32 s54, s54, 2
    s_mul_i32 s54, s54, 128
    s_add_u32 s54, s54, s55
    v_add_u32 v12, s54, v60
    s_mov_b32 s36, s18
    s_mov_b32 s37, s19
    s_mov_b32 s38, 917504
    s_mov_b32 s39, 0x00020000
    s_lshl_b32 s50, s47, 11
    s_add_u32 s50, s50, 16777216
    s_lshl_b32 s51, s48, 7
    s_and_b32 s54, s47, 3
    s_lshl_b32 s54, s54, 1
    s_add_u32 s54, s54, s48
    s_lshl_b32 s54, s54, 1
    s_sub_u32 s55, s54, 14
    s_cmp_ge_u32 s54, 14
    s_cselect_b32 s54, s55, s54
    s_mul_i32 s54, s54, 1
    s_mov_b32 s98, s50
    s_add_u32 s99, s50, 3670016
    s_mov_b32 s100, s51
    s_add_u32 s101, s51, 917504
    s_mul_i32 s55, s54, 262144
    s_add_u32 s50, s50, s55
    s_mul_i32 s55, s54, 65536
    s_add_u32 s51, s51, s55
    s_add_u32 m0, s27, 32768
    s_nop 0
    buffer_load_dwordx4 v12, s[36:39], s51 offen offset:0 lds
    s_add_u32 s51, s51, 32768
    s_cmp_eq_u32 s51, s101
    s_cselect_b32 s51, s100, s51
    s_add_u32 m0, s27, 36864
    s_nop 0
    buffer_load_dwordx4 v12, s[36:39], s51 offen offset:0 lds
    s_add_u32 s51, s51, 32768
    s_cmp_eq_u32 s51, s101
    s_cselect_b32 s51, s100, s51
    s_add_u32 m0, s27, 40960
    s_nop 0
    buffer_load_dwordx4 v12, s[36:39], s51 offen offset:0 lds
    s_add_u32 s51, s51, 32768
    s_cmp_eq_u32 s51, s101
    s_cselect_b32 s51, s100, s51
    s_add_u32 m0, s27, 45056
    s_nop 0
    buffer_load_dwordx4 v12, s[36:39], s51 offen offset:0 lds
    s_add_u32 s51, s51, 32768
    s_cmp_eq_u32 s51, s101
    s_cselect_b32 s51, s100, s51
    s_add_u32 m0, s27, 49152
    s_nop 0
    buffer_load_dwordx4 v12, s[36:39], s51 offen offset:0 lds
    s_add_u32 s51, s51, 32768
    s_cmp_eq_u32 s51, s101
    s_cselect_b32 s51, s100, s51
    s_add_u32 m0, s27, 53248
    s_nop 0
    buffer_load_dwordx4 v12, s[36:39], s51 offen offset:0 lds
    s_add_u32 s51, s51, 32768
    s_cmp_eq_u32 s51, s101
    s_cselect_b32 s51, s100, s51
    s_add_u32 m0, s27, 57344
    s_nop 0
    buffer_load_dwordx4 v12, s[36:39], s51 offen offset:0 lds
    s_add_u32 s51, s51, 32768
    s_cmp_eq_u32 s51, s101
    s_cselect_b32 s51, s100, s51
    s_add_u32 m0, s27, 61440
    s_nop 0
    buffer_load_dwordx4 v12, s[36:39], s51 offen offset:0 lds
    s_add_u32 s51, s51, 32768
    s_cmp_eq_u32 s51, s101
    s_cselect_b32 s51, s100, s51
    s_add_u32 s54, s47, 48
    s_lshl_b32 s55, s54, 8
    s_add_u32 s55, s55, 22020096
    s_cmp_lt_u32 s3, 224
    s_cbranch_scc0 BL_NS4
    s_barrier
    s_cmp_eq_u32 s49, 0
    s_cbranch_scc0 BL_G4
    s_lshl_b32 s62, s54, 8
    s_add_u32 s62, s62, 22020096
    v_mov_b32 v60, 1
    v_mov_b32 v61, 0
    s_mov_b64 exec, 1
    buffer_atomic_add v60, v61, s[28:31], s62 offen sc1
    s_mov_b64 exec, -1
BL_NS4:
    s_cmp_eq_u32 s49, 0
    s_cbranch_scc0 BL_G4
    v_cmp_ne_u32 vcc, 1, v7
    s_nop 4
    s_cbranch_vccz BLC_ZOK
    s_mov_b32 s62, 0
BLC_Z_P:
    buffer_load_dword v7, v6, s[40:43], 0 offen sc1
    s_waitcnt vmcnt(0)
    v_cmp_ne_u32 vcc, 1, v7
    s_add_u32 s62, s62, 1
    s_cmp_gt_u32 s62, 20000
    s_cbranch_scc1 BLC_Z_X
    s_cbranch_vccz BLC_Z_X
    s_sleep 0
    s_branch BLC_Z_P
BLC_Z_X:
BLC_ZOK:
    s_mov_b32 s62, 0
BL_S4_P:
    buffer_load_dword v60, v6, s[28:31], s55 offen sc1
    s_waitcnt vmcnt(0)
    v_cmp_ne_u32 vcc, 7, v60
    s_add_u32 s62, s62, 1
    s_cmp_gt_u32 s62, 20000
    s_cbranch_scc1 BL_S4_X
    s_cbranch_vccz BL_S4_X
    s_sleep 0
    s_branch BL_S4_P
BL_S4_X:
BL_G4:
    s_barrier
    s_add_u32 m0, s26, 0
    s_nop 0
    buffer_load_dwordx4 v8, s[28:31], s50 offen offset:0 lds
    buffer_load_dwordx4 v8, s[28:31], s50 offen offset:1024 lds
    s_add_u32 s50, s50, 262144
    s_cmp_eq_u32 s50, s99
    s_cselect_b32 s50, s98, s50
    s_add_u32 m0, s26, 8192
    s_nop 0
    buffer_load_dwordx4 v8, s[28:31], s50 offen offset:0 lds
    buffer_load_dwordx4 v8, s[28:31], s50 offen offset:1024 lds
    s_add_u32 s50, s50, 262144
    s_cmp_eq_u32 s50, s99
    s_cselect_b32 s50, s98, s50
    s_add_u32 m0, s26, 16384
    s_nop 0
    buffer_load_dwordx4 v8, s[28:31], s50 offen offset:0 lds
    buffer_load_dwordx4 v8, s[28:31], s50 offen offset:1024 lds
    s_add_u32 s50, s50, 262144
    s_cmp_eq_u32 s50, s99
    s_cselect_b32 s50, s98, s50
    s_add_u32 m0, s26, 24576
    s_nop 0
    buffer_load_dwordx4 v8, s[28:31], s50 offen offset:0 lds
    buffer_load_dwordx4 v8, s[28:31], s50 offen offset:1024 lds
    s_add_u32 s50, s50, 262144
    s_cmp_eq_u32 s50, s99
    s_cselect_b32 s50, s98, s50
    v_and_b32 v61, 1, v1
    v_lshlrev_b32 v61, 8, v61
    s_and_b32 s59, s3, 7
    s_lshl_b32 s59, s59, 9
    s_add_u32 s59, s59, 22040576
    v_mov_b32 v56, 0
    s_waitcnt vmcnt(6)
    s_barrier
    s_mov_b32 s52, 0
B3_L_LOOP:
    s_waitcnt vmcnt(4)
    s_barrier
    s_add_u32 m0, s26, 0
    s_nop 0
    buffer_load_dwordx4 v8, s[28:31], s50 offen offset:0 lds
    buffer_load_dwordx4 v8, s[28:31], s50 offen offset:1024 lds
    s_add_u32 s50, s50, 262144
    s_cmp_eq_u32 s50, s99
    s_cselect_b32 s50, s98, s50
    s_add_u32 m0, s27, 32768
    s_nop 0
    buffer_load_dwordx4 v12, s[36:39], s51 offen offset:0 lds
    s_add_u32 s51, s51, 32768
    s_cmp_eq_u32 s51, s101
    s_cselect_b32 s51, s100, s51
    s_add_u32 m0, s27, 36864
    s_nop 0
    buffer_load_dwordx4 v12, s[36:39], s51 offen offset:0 lds
    s_add_u32 s51, s51, 32768
    s_cmp_eq_u32 s51, s101
    s_cselect_b32 s51, s100, s51
    s_waitcnt vmcnt(6)
    s_barrier
    s_add_u32 m0, s26, 8192
    s_nop 0
    buffer_load_dwordx4 v8, s[28:31], s50 offen offset:0 lds
    buffer_load_dwordx4 v8, s[28:31], s50 offen offset:1024 lds
    s_add_u32 s50, s50, 262144
    s_cmp_eq_u32 s50, s99
    s_cselect_b32 s50, s98, s50
    s_add_u32 m0, s27, 40960
    s_nop 0
    buffer_load_dwordx4 v12, s[36:39], s51 offen offset:0 lds
    s_add_u32 s51, s51, 32768
    s_cmp_eq_u32 s51, s101
    s_cselect_b32 s51, s100, s51
    s_add_u32 m0, s27, 45056
    s_nop 0
    buffer_load_dwordx4 v12, s[36:39], s51 offen offset:0 lds
    s_add_u32 s51, s51, 32768
    s_cmp_eq_u32 s51, s101
    s_cselect_b32 s51, s100, s51
    s_add_u32 s52, s52, 1
    s_cmp_lt_u32 s52, 3
    s_cbranch_scc0 B3_L_DONE
    s_waitcnt vmcnt(8)
    s_barrier
    s_add_u32 m0, s26, 16384
    s_nop 0
    buffer_load_dwordx4 v8, s[28:31], s50 offen offset:0 lds
    buffer_load_dwordx4 v8, s[28:31], s50 offen offset:1024 lds
    s_add_u32 s50, s50, 262144
    s_cmp_eq_u32 s50, s99
    s_cselect_b32 s50, s98, s50
    s_add_u32 m0, s27, 49152
    s_nop 0
    buffer_load_dwordx4 v12, s[36:39], s51 offen offset:0 lds
    s_add_u32 s51, s51, 32768
    s_cmp_eq_u32 s51, s101
    s_cselect_b32 s51, s100, s51
    s_add_u32 m0, s27, 53248
    s_nop 0
    buffer_load_dwordx4 v12, s[36:39], s51 offen offset:0 lds
    s_add_u32 s51, s51, 32768
    s_cmp_eq_u32 s51, s101
    s_cselect_b32 s51, s100, s51
    s_waitcnt vmcnt(8)
    s_barrier
    s_add_u32 m0, s26, 24576
    s_nop 0
    buffer_load_dwordx4 v8, s[28:31], s50 offen offset:0 lds
    buffer_load_dwordx4 v8, s[28:31], s50 offen offset:1024 lds
    s_add_u32 s50, s50, 262144
    s_cmp_eq_u32 s50, s99
    s_cselect_b32 s50, s98, s50
    s_add_u32 m0, s27, 57344
    s_nop 0
    buffer_load_dwordx4 v12, s[36:39], s51 offen offset:0 lds
    s_add_u32 s51, s51, 32768
    s_cmp_eq_u32 s51, s101
    s_cselect_b32 s51, s100, s51
    s_add_u32 m0, s27, 61440
    s_nop 0
    buffer_load_dwordx4 v12, s[36:39], s51 offen offset:0 lds
    s_add_u32 s51, s51, 32768
    s_cmp_eq_u32 s51, s101
    s_cselect_b32 s51, s100, s51
    s_branch B3_L_LOOP
B3_L_DONE:
    s_waitcnt vmcnt(8)
    s_barrier
    s_waitcnt vmcnt(4)
    s_barrier
    buffer_load_dword v56, v61, s[28:31], s59 offen sc1
    s_waitcnt vmcnt(1)
    s_barrier
    s_barrier
    s_mov_b32 s36, s8
    s_mov_b32 s37, s9
    s_mov_b32 s38, 524288
    s_mov_b32 s39, 0x00020000
    s_lshl_b32 s50, s47, 11
    s_add_u32 s50, s50, 14680064
    s_lshl_b32 s51, s48, 7
    s_lshl_b32 s54, s47, 1
    s_add_u32 s54, s54, s48
    s_and_b32 s54, s54, 7
    s_mov_b32 s98, s50
    s_add_u32 s99, s50, 2097152
    s_mov_b32 s100, s51
    s_add_u32 s101, s51, 524288
    s_mul_i32 s55, s54, 262144
    s_add_u32 s50, s50, s55
    s_mul_i32 s55, s54, 65536
    s_add_u32 s51, s51, s55
    s_waitcnt vmcnt(0)
    v_cmp_ne_u32 vcc, 16, v56
    s_nop 4
    s_cbranch_vccnz BL_SLOW
    s_add_u32 m0, s26, 0
    s_nop 0
    buffer_load_dwordx4 v8, s[28:31], s50 offen offset:0 lds
    buffer_load_dwordx4 v8, s[28:31], s50 offen offset:1024 lds
    s_add_u32 s50, s50, 262144
    s_cmp_eq_u32 s50, s99
    s_cselect_b32 s50, s98, s50
    s_add_u32 m0, s27, 49152
    s_nop 0
    buffer_load_dwordx4 v12, s[36:39], s51 offen offset:0 lds
    s_add_u32 s51, s51, 32768
    s_cmp_eq_u32 s51, s101
    s_cselect_b32 s51, s100, s51
    s_add_u32 m0, s27, 53248
    s_nop 0
    buffer_load_dwordx4 v12, s[36:39], s51 offen offset:0 lds
    s_add_u32 s51, s51, 32768
    s_cmp_eq_u32 s51, s101
    s_cselect_b32 s51, s100, s51
    s_add_u32 m0, s26, 8192
    s_nop 0
    buffer_load_dwordx4 v8, s[28:31], s50 offen offset:0 lds
    buffer_load_dwordx4 v8, s[28:31], s50 offen offset:1024 lds
    s_add_u32 s50, s50, 262144
    s_cmp_eq_u32 s50, s99
    s_cselect_b32 s50, s98, s50
    s_add_u32 m0, s27, 57344
    s_nop 0
    buffer_load_dwordx4 v12, s[36:39], s51 offen offset:0 lds
    s_add_u32 s51, s51, 32768
    s_cmp_eq_u32 s51, s101
    s_cselect_b32 s51, s100, s51
    s_add_u32 m0, s27, 61440
    s_nop 0
    buffer_load_dwordx4 v12, s[36:39], s51 offen offset:0 lds
    s_add_u32 s51, s51, 32768
    s_cmp_eq_u32 s51, s101
    s_cselect_b32 s51, s100, s51
    s_add_u32 m0, s26, 16384
    s_nop 0
    buffer_load_dwordx4 v8, s[28:31], s50 offen offset:0 lds
    buffer_load_dwordx4 v8, s[28:31], s50 offen offset:1024 lds
    s_add_u32 s50, s50, 262144
    s_cmp_eq_u32 s50, s99
    s_cselect_b32 s50, s98, s50
    s_add_u32 m0, s27, 65536
    s_nop 0
    buffer_load_dwordx4 v12, s[36:39], s51 offen offset:0 lds
    s_add_u32 s51, s51, 32768
    s_cmp_eq_u32 s51, s101
    s_cselect_b32 s51, s100, s51
    s_add_u32 m0, s27, 69632
    s_nop 0
    buffer_load_dwordx4 v12, s[36:39], s51 offen offset:0 lds
    s_add_u32 s51, s51, 32768
    s_cmp_eq_u32 s51, s101
    s_cselect_b32 s51, s100, s51
    s_add_u32 m0, s26, 24576
    s_nop 0
    buffer_load_dwordx4 v8, s[28:31], s50 offen offset:0 lds
    buffer_load_dwordx4 v8, s[28:31], s50 offen offset:1024 lds
    s_add_u32 s50, s50, 262144
    s_cmp_eq_u32 s50, s99
    s_cselect_b32 s50, s98, s50
    s_add_u32 m0, s27, 73728
    s_nop 0
    buffer_load_dwordx4 v12, s[36:39], s51 offen offset:0 lds
    s_add_u32 s51, s51, 32768
    s_cmp_eq_u32 s51, s101
    s_cselect_b32 s51, s100, s51
    s_add_u32 m0, s27, 77824
    s_nop 0
    buffer_load_dwordx4 v12, s[36:39], s51 offen offset:0 lds
    s_add_u32 s51, s51, 32768
    s_cmp_eq_u32 s51, s101
    s_cselect_b32 s51, s100, s51
    s_add_u32 m0, s26, 32768
    s_nop 0
    buffer_load_dwordx4 v8, s[28:31], s50 offen offset:0 lds
    buffer_load_dwordx4 v8, s[28:31], s50 offen offset:1024 lds
    s_add_u32 s50, s50, 262144
    s_cmp_eq_u32 s50, s99
    s_cselect_b32 s50, s98, s50
    s_add_u32 m0, s26, 40960
    s_nop 0
    buffer_load_dwordx4 v8, s[28:31], s50 offen offset:0 lds
    buffer_load_dwordx4 v8, s[28:31], s50 offen offset:1024 lds
    s_add_u32 s50, s50, 262144
    s_cmp_eq_u32 s50, s99
    s_cselect_b32 s50, s98, s50
    s_barrier
    s_waitcnt vmcnt(16)
    s_barrier
    s_waitcnt vmcnt(12)
    s_barrier
    s_add_u32 m0, s26, 0
    s_nop 0
    buffer_load_dwordx4 v8, s[28:31], s50 offen offset:0 lds
    buffer_load_dwordx4 v8, s[28:31], s50 offen offset:1024 lds
    s_add_u32 s50, s50, 262144
    s_cmp_eq_u32 s50, s99
    s_cselect_b32 s50, s98, s50
    s_add_u32 m0, s27, 49152
    s_nop 0
    buffer_load_dwordx4 v12, s[36:39], s51 offen offset:0 lds
    s_add_u32 s51, s51, 32768
    s_cmp_eq_u32 s51, s101
    s_cselect_b32 s51, s100, s51
    s_add_u32 m0, s27, 53248
    s_nop 0
    buffer_load_dwordx4 v12, s[36:39], s51 offen offset:0 lds
    s_add_u32 s51, s51, 32768
    s_cmp_eq_u32 s51, s101
    s_cselect_b32 s51, s100, s51
    s_waitcnt vmcnt(12)
    s_barrier
    s_add_u32 m0, s26, 8192
    s_nop 0
    buffer_load_dwordx4 v8, s[28:31], s50 offen offset:0 lds
    buffer_load_dwordx4 v8, s[28:31], s50 offen offset:1024 lds
    s_add_u32 s50, s50, 262144
    s_cmp_eq_u32 s50, s99
    s_cselect_b32 s50, s98, s50
    s_add_u32 m0, s27, 57344
    s_nop 0
    buffer_load_dwordx4 v12, s[36:39], s51 offen offset:0 lds
    s_add_u32 s51, s51, 32768
    s_cmp_eq_u32 s51, s101
    s_cselect_b32 s51, s100, s51
    s_add_u32 m0, s27, 61440
    s_nop 0
    buffer_load_dwordx4 v12, s[36:39], s51 offen offset:0 lds
    s_add_u32 s51, s51, 32768
    s_cmp_eq_u32 s51, s101
    s_cselect_b32 s51, s100, s51
    s_waitcnt vmcnt(12)
    s_barrier
    s_add_u32 m0, s27, 65536
    s_nop 0
    buffer_load_dwordx4 v12, s[36:39], s51 offen offset:0 lds
    s_add_u32 s51, s51, 32768
    s_cmp_eq_u32 s51, s101
    s_cselect_b32 s51, s100, s51
    s_add_u32 m0, s27, 69632
    s_nop 0
    buffer_load_dwordx4 v12, s[36:39], s51 offen offset:0 lds
    s_add_u32 s51, s51, 32768
    s_cmp_eq_u32 s51, s101
    s_cselect_b32 s51, s100, s51
    s_waitcnt vmcnt(6)
    s_barrier
    s_add_u32 m0, s27, 73728
    s_nop 0
    buffer_load_dwordx4 v12, s[36:39], s51 offen offset:0 lds
    s_add_u32 s51, s51, 32768
    s_cmp_eq_u32 s51, s101
    s_cselect_b32 s51, s100, s51
    s_add_u32 m0, s27, 77824
    s_nop 0
    buffer_load_dwordx4 v12, s[36:39], s51 offen offset:0 lds
    s_add_u32 s51, s51, 32768
    s_cmp_eq_u32 s51, s101
    s_cselect_b32 s51, s100, s51
    s_waitcnt vmcnt(4)
    s_barrier
    s_waitcnt vmcnt(2)
    s_barrier
    s_waitcnt vmcnt(0)
    s_barrier
    s_barrier
    s_branch BL_FEND
BL_SLOW:
    s_add_u32 m0, s27, 49152
    s_nop 0
    buffer_load_dwordx4 v12, s[36:39], s51 offen offset:0 lds
    s_add_u32 s51, s51, 32768
    s_cmp_eq_u32 s51, s101
    s_cselect_b32 s51, s100, s51
    s_add_u32 m0, s27, 53248
    s_nop 0
    buffer_load_dwordx4 v12, s[36:39], s51 offen offset:0 lds
    s_add_u32 s51, s51, 32768
    s_cmp_eq_u32 s51, s101
    s_cselect_b32 s51, s100, s51
    s_add_u32 m0, s27, 57344
    s_nop 0
    buffer_load_dwordx4 v12, s[36:39], s51 offen offset:0 lds
    s_add_u32 s51, s51, 32768
    s_cmp_eq_u32 s51, s101
    s_cselect_b32 s51, s100, s51
    s_add_u32 m0, s27, 61440
    s_nop 0
    buffer_load_dwordx4 v12, s[36:39], s51 offen offset:0 lds
    s_add_u32 s51, s51, 32768
    s_cmp_eq_u32 s51, s101
    s_cselect_b32 s51, s100, s51
    s_add_u32 m0, s27, 65536
    s_nop 0
    buffer_load_dwordx4 v12, s[36:39], s51 offen offset:0 lds
    s_add_u32 s51, s51, 32768
    s_cmp_eq_u32 s51, s101
    s_cselect_b32 s51, s100, s51
    s_add_u32 m0, s27, 69632
    s_nop 0
    buffer_load_dwordx4 v12, s[36:39], s51 offen offset:0 lds
    s_add_u32 s51, s51, 32768
    s_cmp_eq_u32 s51, s101
    s_cselect_b32 s51, s100, s51
    s_add_u32 m0, s27, 73728
    s_nop 0
    buffer_load_dwordx4 v12, s[36:39], s51 offen offset:0 lds
    s_add_u32 s51, s51, 32768
    s_cmp_eq_u32 s51, s101
    s_cselect_b32 s51, s100, s51
    s_add_u32 m0, s27, 77824
    s_nop 0
    buffer_load_dwordx4 v12, s[36:39], s51 offen offset:0 lds
    s_add_u32 s51, s51, 32768
    s_cmp_eq_u32 s51, s101
    s_cselect_b32 s51, s100, s51
    s_mov_b32 s62, 0
BL_S5_P:
    buffer_load_dword v60, v61, s[28:31], s59 offen sc1
    s_waitcnt vmcnt(0)
    v_cmp_ne_u32 vcc, 16, v60
    s_add_u32 s62, s62, 1
    s_cmp_gt_u32 s62, 20000
    s_cbranch_scc1 BL_S5_X
    s_cbranch_vccz BL_S5_X
    s_sleep 0
    s_branch BL_S5_P
BL_S5_X:
BL_G5:
    s_add_u32 m0, s26, 0
    s_nop 0
    buffer_load_dwordx4 v8, s[28:31], s50 offen offset:0 lds
    buffer_load_dwordx4 v8, s[28:31], s50 offen offset:1024 lds
    s_add_u32 s50, s50, 262144
    s_cmp_eq_u32 s50, s99
    s_cselect_b32 s50, s98, s50
    s_add_u32 m0, s26, 8192
    s_nop 0
    buffer_load_dwordx4 v8, s[28:31], s50 offen offset:0 lds
    buffer_load_dwordx4 v8, s[28:31], s50 offen offset:1024 lds
    s_add_u32 s50, s50, 262144
    s_cmp_eq_u32 s50, s99
    s_cselect_b32 s50, s98, s50
    s_add_u32 m0, s26, 16384
    s_nop 0
    buffer_load_dwordx4 v8, s[28:31], s50 offen offset:0 lds
    buffer_load_dwordx4 v8, s[28:31], s50 offen offset:1024 lds
    s_add_u32 s50, s50, 262144
    s_cmp_eq_u32 s50, s99
    s_cselect_b32 s50, s98, s50
    s_add_u32 m0, s26, 24576
    s_nop 0
    buffer_load_dwordx4 v8, s[28:31], s50 offen offset:0 lds
    buffer_load_dwordx4 v8, s[28:31], s50 offen offset:1024 lds
    s_add_u32 s50, s50, 262144
    s_cmp_eq_u32 s50, s99
    s_cselect_b32 s50, s98, s50
    s_add_u32 m0, s26, 32768
    s_nop 0
    buffer_load_dwordx4 v8, s[28:31], s50 offen offset:0 lds
    buffer_load_dwordx4 v8, s[28:31], s50 offen offset:1024 lds
    s_add_u32 s50, s50, 262144
    s_cmp_eq_u32 s50, s99
    s_cselect_b32 s50, s98, s50
    s_add_u32 m0, s26, 40960
    s_nop 0
    buffer_load_dwordx4 v8, s[28:31], s50 offen offset:0 lds
    buffer_load_dwordx4 v8, s[28:31], s50 offen offset:1024 lds
    s_add_u32 s50, s50, 262144
    s_cmp_eq_u32 s50, s99
    s_cselect_b32 s50, s98, s50
    s_barrier
    s_waitcnt vmcnt(10)
    s_barrier
    s_waitcnt vmcnt(8)
    s_barrier
    s_add_u32 m0, s26, 0
    s_nop 0
    buffer_load_dwordx4 v8, s[28:31], s50 offen offset:0 lds
    buffer_load_dwordx4 v8, s[28:31], s50 offen offset:1024 lds
    s_add_u32 s50, s50, 262144
    s_cmp_eq_u32 s50, s99
    s_cselect_b32 s50, s98, s50
    s_add_u32 m0, s27, 49152
    s_nop 0
    buffer_load_dwordx4 v12, s[36:39], s51 offen offset:0 lds
    s_add_u32 s51, s51, 32768
    s_cmp_eq_u32 s51, s101
    s_cselect_b32 s51, s100, s51
    s_add_u32 m0, s27, 53248
    s_nop 0
    buffer_load_dwordx4 v12, s[36:39], s51 offen offset:0 lds
    s_add_u32 s51, s51, 32768
    s_cmp_eq_u32 s51, s101
    s_cselect_b32 s51, s100, s51
    s_waitcnt vmcnt(10)
    s_barrier
    s_add_u32 m0, s26, 8192
    s_nop 0
    buffer_load_dwordx4 v8, s[28:31], s50 offen offset:0 lds
    buffer_load_dwordx4 v8, s[28:31], s50 offen offset:1024 lds
    s_add_u32 s50, s50, 262144
    s_cmp_eq_u32 s50, s99
    s_cselect_b32 s50, s98, s50
    s_add_u32 m0, s27, 57344
    s_nop 0
    buffer_load_dwordx4 v12, s[36:39], s51 offen offset:0 lds
    s_add_u32 s51, s51, 32768
    s_cmp_eq_u32 s51, s101
    s_cselect_b32 s51, s100, s51
    s_add_u32 m0, s27, 61440
    s_nop 0
    buffer_load_dwordx4 v12, s[36:39], s51 offen offset:0 lds
    s_add_u32 s51, s51, 32768
    s_cmp_eq_u32 s51, s101
    s_cselect_b32 s51, s100, s51
    s_waitcnt vmcnt(12)
    s_barrier
    s_add_u32 m0, s27, 65536
    s_nop 0
    buffer_load_dwordx4 v12, s[36:39], s51 offen offset:0 lds
    s_add_u32 s51, s51, 32768
    s_cmp_eq_u32 s51, s101
    s_cselect_b32 s51, s100, s51
    s_add_u32 m0, s27, 69632
    s_nop 0
    buffer_load_dwordx4 v12, s[36:39], s51 offen offset:0 lds
    s_add_u32 s51, s51, 32768
    s_cmp_eq_u32 s51, s101
    s_cselect_b32 s51, s100, s51
    s_waitcnt vmcnt(6)
    s_barrier
    s_add_u32 m0, s27, 73728
    s_nop 0
    buffer_load_dwordx4 v12, s[36:39], s51 offen offset:0 lds
    s_add_u32 s51, s51, 32768
    s_cmp_eq_u32 s51, s101
    s_cselect_b32 s51, s100, s51
    s_add_u32 m0, s27, 77824
    s_nop 0
    buffer_load_dwordx4 v12, s[36:39], s51 offen offset:0 lds
    s_add_u32 s51, s51, 32768
    s_cmp_eq_u32 s51, s101
    s_cselect_b32 s51, s100, s51
    s_waitcnt vmcnt(4)
    s_barrier
    s_waitcnt vmcnt(2)
    s_barrier
    s_waitcnt vmcnt(0)
    s_barrier
    s_barrier
BL_FEND:
    s_endpgm
M_BC:
    s_setprio 1
    v_and_b32 v112, 31, v1
    v_lshrrev_b32 v113, 5, v1
    v_bfe_u32 v114, v112, 1, 3
    v_xor_b32 v114, v114, v113
    v_lshlrev_b32 v114, 4, v114
    v_lshl_add_u32 v2, v112, 7, v114
    v_bfe_u32 v114, v1, 2, 2
    v_lshl_add_u32 v115, v113, 3, v114
    v_lshlrev_b32 v115, 7, v115
    v_bfe_u32 v116, v1, 3, 1
    v_lshl_add_u32 v115, v116, 6, v115
    v_bfe_u32 v116, v1, 4, 1
    v_lshl_add_u32 v115, v116, 5, v115
    v_and_b32 v116, 1, v1
    v_lshl_add_u32 v115, v116, 4, v115
    v_bfe_u32 v116, v1, 1, 1
    v_lshl_add_u32 v3, v116, 3, v115
    s_lshr_b32 s54, s44, 1
    s_lshl_b32 s54, s54, 5
    s_lshl_b32 s55, s47, 6
    s_add_u32 s54, s54, s55
    v_and_b32 v112, 31, v1
    v_add_u32 v13, s54, v112
    v_lshrrev_b32 v113, 5, v1
    v_lshlrev_b32 v113, 4, v113
    v_lshl_add_u32 v12, v13, 5, v113
    v_lshl_add_u32 v14, v13, 10, v113
    s_waitcnt lgkmcnt(0)
    s_mov_b32 s28, s24
    s_mov_b32 s29, s25
    s_mov_b32 s30, 33554432
    s_mov_b32 s31, 0x00020000
    s_cmp_lt_u32 s3, 224
    s_cbranch_scc1 BC_Z
    s_branch BC_H
BC_Z:
    v_mov_b32 v16, 0
    v_mov_b32 v17, 0
    v_mov_b32 v18, 0
    v_mov_b32 v19, 0
    v_mov_b32 v20, 0
    v_mov_b32 v21, 0
    v_mov_b32 v22, 0
    v_mov_b32 v23, 0
    v_mov_b32 v24, 0
    v_mov_b32 v25, 0
    v_mov_b32 v26, 0
    v_mov_b32 v27, 0
    v_mov_b32 v28, 0
    v_mov_b32 v29, 0
    v_mov_b32 v30, 0
    v_mov_b32 v31, 0
    v_mov_b32 v32, 0
    v_mov_b32 v33, 0
    v_mov_b32 v34, 0
    v_mov_b32 v35, 0
    v_mov_b32 v36, 0
    v_mov_b32 v37, 0
    v_mov_b32 v38, 0
    v_mov_b32 v39, 0
    v_mov_b32 v40, 0
    v_mov_b32 v41, 0
    v_mov_b32 v42, 0
    v_mov_b32 v43, 0
    v_mov_b32 v44, 0
    v_mov_b32 v45, 0
    v_mov_b32 v46, 0
    v_mov_b32 v47, 0
    v_mov_b32 v48, 0
    v_mov_b32 v49, 0
    v_mov_b32 v50, 0
    v_mov_b32 v51, 0
    v_mov_b32 v52, 0
    v_mov_b32 v53, 0
    v_mov_b32 v54, 0
    v_mov_b32 v55, 0
    v_mov_b32 v56, 0
    v_mov_b32 v57, 0
    v_mov_b32 v58, 0
    v_mov_b32 v59, 0
    v_mov_b32 v60, 0
    v_mov_b32 v61, 0
    v_mov_b32 v62, 0
    v_mov_b32 v63, 0
    v_mov_b32 v64, 0
    v_mov_b32 v65, 0
    v_mov_b32 v66, 0
    v_mov_b32 v67, 0
    v_mov_b32 v68, 0
    v_mov_b32 v69, 0
    v_mov_b32 v70, 0
    v_mov_b32 v71, 0
    v_mov_b32 v72, 0
    v_mov_b32 v73, 0
    v_mov_b32 v74, 0
    v_mov_b32 v75, 0
    v_mov_b32 v76, 0
    v_mov_b32 v77, 0
    v_mov_b32 v78, 0
    v_mov_b32 v79, 0
    s_mul_i32 s54, s45, 14336
    s_lshl_b32 s55, s46, 10
    s_add_u32 s54, s54, s55
    s_add_u32 s54, s54, 21037056
    v_lshlrev_b32 v112, 2, v0
    buffer_store_dword v16, v112, s[28:31], s54 offen sc1
    s_lshr_b32 s54, s44, 1
    s_xor_b32 s56, s54, s44
    s_and_b32 s56, s56, 1
    s_lshl_b32 s57, s56, 5
    s_lshl_b32 s56, s56, 11
    s_mul_i32 s54, s54, 8192
    v_add_u32 v4, s54, v2
    v_xor_b32 v4, s57, v4
    v_xor_b32 v5, 32, v4
    v_xor_b32 v6, 64, v4
    v_xor_b32 v7, 96, v4
    s_and_b32 s54, s44, 1
    s_and_b32 s55, s54, 1
    s_lshl_b32 s55, s55, 6
    s_lshr_b32 s54, s54, 1
    s_lshl_b32 s54, s54, 12
    s_add_u32 s54, s54, 49152
    s_add_u32 s54, s54, s56
    v_xor_b32 v8, s55, v3
    v_add_u32 v8, s54, v8
    v_xor_b32 v10, 2048, v8
    s_and_b32 s54, s44, 1
    s_add_u32 s54, s54, 2
    s_and_b32 s55, s54, 1
    s_lshl_b32 s55, s55, 6
    s_lshr_b32 s54, s54, 1
    s_lshl_b32 s54, s54, 12
    s_add_u32 s54, s54, 49152
    s_add_u32 s54, s54, s56
    v_xor_b32 v9, s55, v3
    v_add_u32 v9, s54, v9
    v_xor_b32 v11, 2048, v9
    v_mov_b32 v124, 0
    v_mov_b32 v125, 0
    v_mov_b32 v126, 0
    v_mov_b32 v127, 0
    v_mov_b32 v112, 0
    v_mov_b32 v113, 0
    v_mov_b32 v114, 0
    v_mov_b32 v115, 0
    v_mov_b32 v116, 0
    v_mov_b32 v117, 0
    v_mov_b32 v118, 0
    v_mov_b32 v119, 0
    v_bfe_u32 v120, v1, 4, 1
    v_xor_b32 v120, v120, v1
    v_and_b32 v120, 1, v120
    v_add_u32 v120, -1, v120
    v_and_b32 v120, 0x3f803f80, v120
    v_mov_b32 v121, v120
    v_mov_b32 v122, v120
    v_mov_b32 v123, v120
    s_barrier
    ds_read_b128 v[80:83], v4 offset:0
    ds_read_b64_tr_b16 v[88:89], v8 offset:0
    ds_read_b64_tr_b16 v[90:91], v8 offset:512
    ds_read_b128 v[84:87], v4 offset:4096
    ds_read_b64_tr_b16 v[92:93], v9 offset:0
    ds_read_b64_tr_b16 v[94:95], v9 offset:512
    s_mov_b32 s52, 0
B1_C_LOOP:
    s_waitcnt lgkmcnt(3)
    v_mfma_f32_32x32x16_bf16 v[16:31], v[88:91], v[80:83], v[16:31]
    ds_read_b128 v[96:99], v5 offset:0
    ds_read_b64_tr_b16 v[104:105], v10 offset:0
    ds_read_b64_tr_b16 v[106:107], v10 offset:512
    s_waitcnt lgkmcnt(5)
    v_lshlrev_b32 v0, 16, v84
    v_and_b32 v15, 0xffff0000, v84
    v_add_f32 v126, v126, v0
    v_fmac_f32 v127, v0, v0
    v_add_f32 v126, v126, v15
    v_mfma_f32_32x32x16_bf16 v[32:47], v[88:91], v[84:87], v[32:47]
    ds_read_b128 v[100:103], v5 offset:4096
    v_fmac_f32 v127, v15, v15
    v_lshlrev_b32 v0, 16, v85
    v_and_b32 v15, 0xffff0000, v85
    v_add_f32 v126, v126, v0
    v_fmac_f32 v127, v0, v0
    s_waitcnt lgkmcnt(4)
    v_mfma_f32_32x32x16_bf16 v[48:63], v[92:95], v[80:83], v[48:63]
    ds_read_b64_tr_b16 v[108:109], v11 offset:0
    v_add_f32 v126, v126, v15
    v_fmac_f32 v127, v15, v15
    v_lshlrev_b32 v0, 16, v86
    v_and_b32 v15, 0xffff0000, v86
    v_add_f32 v126, v126, v0
    v_mfma_f32_32x32x16_bf16 v[64:79], v[92:95], v[84:87], v[64:79]
    ds_read_b64_tr_b16 v[110:111], v11 offset:512
    v_fmac_f32 v127, v0, v0
    v_add_f32 v126, v126, v15
    v_fmac_f32 v127, v15, v15
    v_lshlrev_b32 v0, 16, v87
    v_and_b32 v15, 0xffff0000, v87
    v_mfma_f32_16x16x32_bf16 v[112:115], v[88:91], v[120:123], v[112:115]
    v_add_f32 v126, v126, v0
    v_fmac_f32 v127, v0, v0
    v_add_f32 v126, v126, v15
    v_fmac_f32 v127, v15, v15
    s_waitcnt lgkmcnt(3)
    v_mfma_f32_32x32x16_bf16 v[16:31], v[104:107], v[96:99], v[16:31]
    v_lshlrev_b32 v0, 16, v96
    v_and_b32 v15, 0xffff0000, v96
    v_add_f32 v124, v124, v0
    v_fmac_f32 v125, v0, v0
    v_add_f32 v124, v124, v15
    v_fmac_f32 v125, v15, v15
    v_lshlrev_b32 v0, 16, v97
    v_and_b32 v15, 0xffff0000, v97
    v_add_f32 v124, v124, v0
    v_fmac_f32 v125, v0, v0
    v_add_f32 v124, v124, v15
    v_fmac_f32 v125, v15, v15
    s_waitcnt lgkmcnt(2)
    v_mfma_f32_32x32x16_bf16 v[32:47], v[104:107], v[100:103], v[32:47]
    v_lshlrev_b32 v0, 16, v98
    v_and_b32 v15, 0xffff0000, v98
    v_add_f32 v124, v124, v0
    v_fmac_f32 v125, v0, v0
    v_add_f32 v124, v124, v15
    v_fmac_f32 v125, v15, v15
    v_lshlrev_b32 v0, 16, v99
    v_and_b32 v15, 0xffff0000, v99
    v_add_f32 v124, v124, v0
    v_fmac_f32 v125, v0, v0
    v_add_f32 v124, v124, v15
    v_fmac_f32 v125, v15, v15
    s_waitcnt lgkmcnt(0)
    s_barrier
    ds_read_b128 v[80:83], v6 offset:0
    ds_read_b64_tr_b16 v[88:89], v8 offset:8192
    ds_read_b64_tr_b16 v[90:91], v8 offset:8704
    v_mfma_f32_32x32x16_bf16 v[48:63], v[108:111], v[96:99], v[48:63]
    ds_read_b128 v[84:87], v6 offset:4096
    v_mfma_f32_32x32x16_bf16 v[64:79], v[108:111], v[100:103], v[64:79]
    ds_read_b64_tr_b16 v[92:93], v9 offset:8192
    v_mfma_f32_16x16x32_bf16 v[116:119], v[108:111], v[120:123], v[116:119]
    ds_read_b64_tr_b16 v[94:95], v9 offset:8704
    s_waitcnt lgkmcnt(3)
    v_mfma_f32_32x32x16_bf16 v[16:31], v[88:91], v[80:83], v[16:31]
    ds_read_b128 v[96:99], v7 offset:0
    ds_read_b64_tr_b16 v[104:105], v10 offset:8192
    ds_read_b64_tr_b16 v[106:107], v10 offset:8704
    s_waitcnt lgkmcnt(5)
    v_lshlrev_b32 v0, 16, v84
    v_and_b32 v15, 0xffff0000, v84
    v_add_f32 v126, v126, v0
    v_fmac_f32 v127, v0, v0
    v_add_f32 v126, v126, v15
    v_mfma_f32_32x32x16_bf16 v[32:47], v[88:91], v[84:87], v[32:47]
    ds_read_b128 v[100:103], v7 offset:4096
    v_fmac_f32 v127, v15, v15
    v_lshlrev_b32 v0, 16, v85
    v_and_b32 v15, 0xffff0000, v85
    v_add_f32 v126, v126, v0
    v_fmac_f32 v127, v0, v0
    s_waitcnt lgkmcnt(4)
    v_mfma_f32_32x32x16_bf16 v[48:63], v[92:95], v[80:83], v[48:63]
    ds_read_b64_tr_b16 v[108:109], v11 offset:8192
    v_add_f32 v126, v126, v15
    v_fmac_f32 v127, v15, v15
    v_lshlrev_b32 v0, 16, v86
    v_and_b32 v15, 0xffff0000, v86
    v_add_f32 v126, v126, v0
    v_mfma_f32_32x32x16_bf16 v[64:79], v[92:95], v[84:87], v[64:79]
    ds_read_b64_tr_b16 v[110:111], v11 offset:8704
    v_fmac_f32 v127, v0, v0
    v_add_f32 v126, v126, v15
    v_fmac_f32 v127, v15, v15
    v_lshlrev_b32 v0, 16, v87
    v_and_b32 v15, 0xffff0000, v87
    v_mfma_f32_16x16x32_bf16 v[112:115], v[88:91], v[120:123], v[112:115]
    v_add_f32 v126, v126, v0
    v_fmac_f32 v127, v0, v0
    v_add_f32 v126, v126, v15
    v_fmac_f32 v127, v15, v15
    s_waitcnt lgkmcnt(3)
    v_mfma_f32_32x32x16_bf16 v[16:31], v[104:107], v[96:99], v[16:31]
    v_lshlrev_b32 v0, 16, v96
    v_and_b32 v15, 0xffff0000, v96
    v_add_f32 v124, v124, v0
    v_fmac_f32 v125, v0, v0
    v_add_f32 v124, v124, v15
    v_fmac_f32 v125, v15, v15
    v_lshlrev_b32 v0, 16, v97
    v_and_b32 v15, 0xffff0000, v97
    v_add_f32 v124, v124, v0
    v_fmac_f32 v125, v0, v0
    v_add_f32 v124, v124, v15
    v_fmac_f32 v125, v15, v15
    s_waitcnt lgkmcnt(2)
    v_mfma_f32_32x32x16_bf16 v[32:47], v[104:107], v[100:103], v[32:47]
    v_lshlrev_b32 v0, 16, v98
    v_and_b32 v15, 0xffff0000, v98
    v_add_f32 v124, v124, v0
    v_fmac_f32 v125, v0, v0
    v_add_f32 v124, v124, v15
    v_fmac_f32 v125, v15, v15
    v_lshlrev_b32 v0, 16, v99
    v_and_b32 v15, 0xffff0000, v99
    v_add_f32 v124, v124, v0
    v_fmac_f32 v125, v0, v0
    v_add_f32 v124, v124, v15
    v_fmac_f32 v125, v15, v15
    s_waitcnt lgkmcnt(0)
    s_barrier
    ds_read_b128 v[80:83], v4 offset:16384
    ds_read_b64_tr_b16 v[88:89], v8 offset:16384
    ds_read_b64_tr_b16 v[90:91], v8 offset:16896
    v_mfma_f32_32x32x16_bf16 v[48:63], v[108:111], v[96:99], v[48:63]
    ds_read_b128 v[84:87], v4 offset:20480
    v_mfma_f32_32x32x16_bf16 v[64:79], v[108:111], v[100:103], v[64:79]
    ds_read_b64_tr_b16 v[92:93], v9 offset:16384
    v_mfma_f32_16x16x32_bf16 v[116:119], v[108:111], v[120:123], v[116:119]
    ds_read_b64_tr_b16 v[94:95], v9 offset:16896
    s_waitcnt lgkmcnt(3)
    v_mfma_f32_32x32x16_bf16 v[16:31], v[88:91], v[80:83], v[16:31]
    ds_read_b128 v[96:99], v5 offset:16384
    ds_read_b64_tr_b16 v[104:105], v10 offset:16384
    ds_read_b64_tr_b16 v[106:107], v10 offset:16896
    s_waitcnt lgkmcnt(5)
    v_lshlrev_b32 v0, 16, v84
    v_and_b32 v15, 0xffff0000, v84
    v_add_f32 v126, v126, v0
    v_fmac_f32 v127, v0, v0
    v_add_f32 v126, v126, v15
    v_mfma_f32_32x32x16_bf16 v[32:47], v[88:91], v[84:87], v[32:47]
    ds_read_b128 v[100:103], v5 offset:20480
    v_fmac_f32 v127, v15, v15
    v_lshlrev_b32 v0, 16, v85
    v_and_b32 v15, 0xffff0000, v85
    v_add_f32 v126, v126, v0
    v_fmac_f32 v127, v0, v0
    s_waitcnt lgkmcnt(4)
    v_mfma_f32_32x32x16_bf16 v[48:63], v[92:95], v[80:83], v[48:63]
    ds_read_b64_tr_b16 v[108:109], v11 offset:16384
    v_add_f32 v126, v126, v15
    v_fmac_f32 v127, v15, v15
    v_lshlrev_b32 v0, 16, v86
    v_and_b32 v15, 0xffff0000, v86
    v_add_f32 v126, v126, v0
    v_mfma_f32_32x32x16_bf16 v[64:79], v[92:95], v[84:87], v[64:79]
    ds_read_b64_tr_b16 v[110:111], v11 offset:16896
    v_fmac_f32 v127, v0, v0
    v_add_f32 v126, v126, v15
    v_fmac_f32 v127, v15, v15
    v_lshlrev_b32 v0, 16, v87
    v_and_b32 v15, 0xffff0000, v87
    v_mfma_f32_16x16x32_bf16 v[112:115], v[88:91], v[120:123], v[112:115]
    v_add_f32 v126, v126, v0
    v_fmac_f32 v127, v0, v0
    v_add_f32 v126, v126, v15
    v_fmac_f32 v127, v15, v15
    s_waitcnt lgkmcnt(3)
    v_mfma_f32_32x32x16_bf16 v[16:31], v[104:107], v[96:99], v[16:31]
    v_lshlrev_b32 v0, 16, v96
    v_and_b32 v15, 0xffff0000, v96
    v_add_f32 v124, v124, v0
    v_fmac_f32 v125, v0, v0
    v_add_f32 v124, v124, v15
    v_fmac_f32 v125, v15, v15
    v_lshlrev_b32 v0, 16, v97
    v_and_b32 v15, 0xffff0000, v97
    v_add_f32 v124, v124, v0
    v_fmac_f32 v125, v0, v0
    v_add_f32 v124, v124, v15
    v_fmac_f32 v125, v15, v15
    s_waitcnt lgkmcnt(2)
    v_mfma_f32_32x32x16_bf16 v[32:47], v[104:107], v[100:103], v[32:47]
    v_lshlrev_b32 v0, 16, v98
    v_and_b32 v15, 0xffff0000, v98
    v_add_f32 v124, v124, v0
    v_fmac_f32 v125, v0, v0
    v_add_f32 v124, v124, v15
    v_fmac_f32 v125, v15, v15
    v_lshlrev_b32 v0, 16, v99
    v_and_b32 v15, 0xffff0000, v99
    v_add_f32 v124, v124, v0
    v_fmac_f32 v125, v0, v0
    v_add_f32 v124, v124, v15
    v_fmac_f32 v125, v15, v15
    s_waitcnt lgkmcnt(0)
    s_barrier
    ds_read_b128 v[80:83], v6 offset:16384
    ds_read_b64_tr_b16 v[88:89], v8 offset:24576
    ds_read_b64_tr_b16 v[90:91], v8 offset:25088
    v_mfma_f32_32x32x16_bf16 v[48:63], v[108:111], v[96:99], v[48:63]
    ds_read_b128 v[84:87], v6 offset:20480
    v_mfma_f32_32x32x16_bf16 v[64:79], v[108:111], v[100:103], v[64:79]
    ds_read_b64_tr_b16 v[92:93], v9 offset:24576
    v_mfma_f32_16x16x32_bf16 v[116:119], v[108:111], v[120:123], v[116:119]
    ds_read_b64_tr_b16 v[94:95], v9 offset:25088
    s_waitcnt lgkmcnt(3)
    v_mfma_f32_32x32x16_bf16 v[16:31], v[88:91], v[80:83], v[16:31]
    ds_read_b128 v[96:99], v7 offset:16384
    ds_read_b64_tr_b16 v[104:105], v10 offset:24576
    ds_read_b64_tr_b16 v[106:107], v10 offset:25088
    s_waitcnt lgkmcnt(5)
    v_lshlrev_b32 v0, 16, v84
    v_and_b32 v15, 0xffff0000, v84
    v_add_f32 v126, v126, v0
    v_fmac_f32 v127, v0, v0
    v_add_f32 v126, v126, v15
    v_mfma_f32_32x32x16_bf16 v[32:47], v[88:91], v[84:87], v[32:47]
    ds_read_b128 v[100:103], v7 offset:20480
    v_fmac_f32 v127, v15, v15
    v_lshlrev_b32 v0, 16, v85
    v_and_b32 v15, 0xffff0000, v85
    v_add_f32 v126, v126, v0
    v_fmac_f32 v127, v0, v0
    s_waitcnt lgkmcnt(4)
    v_mfma_f32_32x32x16_bf16 v[48:63], v[92:95], v[80:83], v[48:63]
    ds_read_b64_tr_b16 v[108:109], v11 offset:24576
    v_add_f32 v126, v126, v15
    v_fmac_f32 v127, v15, v15
    v_lshlrev_b32 v0, 16, v86
    v_and_b32 v15, 0xffff0000, v86
    v_add_f32 v126, v126, v0
    v_mfma_f32_32x32x16_bf16 v[64:79], v[92:95], v[84:87], v[64:79]
    ds_read_b64_tr_b16 v[110:111], v11 offset:25088
    v_fmac_f32 v127, v0, v0
    v_add_f32 v126, v126, v15
    v_fmac_f32 v127, v15, v15
    v_lshlrev_b32 v0, 16, v87
    v_and_b32 v15, 0xffff0000, v87
    v_mfma_f32_16x16x32_bf16 v[112:115], v[88:91], v[120:123], v[112:115]
    v_add_f32 v126, v126, v0
    v_fmac_f32 v127, v0, v0
    v_add_f32 v126, v126, v15
    v_fmac_f32 v127, v15, v15
    s_waitcnt lgkmcnt(3)
    v_mfma_f32_32x32x16_bf16 v[16:31], v[104:107], v[96:99], v[16:31]
    v_lshlrev_b32 v0, 16, v96
    v_and_b32 v15, 0xffff0000, v96
    v_add_f32 v124, v124, v0
    v_fmac_f32 v125, v0, v0
    v_add_f32 v124, v124, v15
    v_fmac_f32 v125, v15, v15
    v_lshlrev_b32 v0, 16, v97
    v_and_b32 v15, 0xffff0000, v97
    v_add_f32 v124, v124, v0
    v_fmac_f32 v125, v0, v0
    v_add_f32 v124, v124, v15
    v_fmac_f32 v125, v15, v15
    s_waitcnt lgkmcnt(2)
    v_mfma_f32_32x32x16_bf16 v[32:47], v[104:107], v[100:103], v[32:47]
    v_lshlrev_b32 v0, 16, v98
    v_and_b32 v15, 0xffff0000, v98
    v_add_f32 v124, v124, v0
    v_fmac_f32 v125, v0, v0
    v_add_f32 v124, v124, v15
    v_fmac_f32 v125, v15, v15
    v_lshlrev_b32 v0, 16, v99
    v_and_b32 v15, 0xffff0000, v99
    v_add_f32 v124, v124, v0
    v_fmac_f32 v125, v0, v0
    v_add_f32 v124, v124, v15
    v_fmac_f32 v125, v15, v15
    s_waitcnt lgkmcnt(0)
    s_barrier
    ds_read_b128 v[80:83], v4 offset:32768
    ds_read_b64_tr_b16 v[88:89], v8 offset:0
    ds_read_b64_tr_b16 v[90:91], v8 offset:512
    v_mfma_f32_32x32x16_bf16 v[48:63], v[108:111], v[96:99], v[48:63]
    ds_read_b128 v[84:87], v4 offset:36864
    v_mfma_f32_32x32x16_bf16 v[64:79], v[108:111], v[100:103], v[64:79]
    ds_read_b64_tr_b16 v[92:93], v9 offset:0
    v_mfma_f32_16x16x32_bf16 v[116:119], v[108:111], v[120:123], v[116:119]
    ds_read_b64_tr_b16 v[94:95], v9 offset:512
    s_add_u32 s52, s52, 1
    s_cmp_lt_u32 s52, 2
    s_cbranch_scc0 B1_C_DONE
    s_waitcnt lgkmcnt(3)
    v_mfma_f32_32x32x16_bf16 v[16:31], v[88:91], v[80:83], v[16:31]
    ds_read_b128 v[96:99], v5 offset:32768
    ds_read_b64_tr_b16 v[104:105], v10 offset:0
    ds_read_b64_tr_b16 v[106:107], v10 offset:512
    s_waitcnt lgkmcnt(5)
    v_lshlrev_b32 v0, 16, v84
    v_and_b32 v15, 0xffff0000, v84
    v_add_f32 v126, v126, v0
    v_fmac_f32 v127, v0, v0
    v_add_f32 v126, v126, v15
    v_mfma_f32_32x32x16_bf16 v[32:47], v[88:91], v[84:87], v[32:47]
    ds_read_b128 v[100:103], v5 offset:36864
    v_fmac_f32 v127, v15, v15
    v_lshlrev_b32 v0, 16, v85
    v_and_b32 v15, 0xffff0000, v85
    v_add_f32 v126, v126, v0
    v_fmac_f32 v127, v0, v0
    s_waitcnt lgkmcnt(4)
    v_mfma_f32_32x32x16_bf16 v[48:63], v[92:95], v[80:83], v[48:63]
    ds_read_b64_tr_b16 v[108:109], v11 offset:0
    v_add_f32 v126, v126, v15
    v_fmac_f32 v127, v15, v15
    v_lshlrev_b32 v0, 16, v86
    v_and_b32 v15, 0xffff0000, v86
    v_add_f32 v126, v126, v0
    v_mfma_f32_32x32x16_bf16 v[64:79], v[92:95], v[84:87], v[64:79]
    ds_read_b64_tr_b16 v[110:111], v11 offset:512
    v_fmac_f32 v127, v0, v0
    v_add_f32 v126, v126, v15
    v_fmac_f32 v127, v15, v15
    v_lshlrev_b32 v0, 16, v87
    v_and_b32 v15, 0xffff0000, v87
    v_mfma_f32_16x16x32_bf16 v[112:115], v[88:91], v[120:123], v[112:115]
    v_add_f32 v126, v126, v0
    v_fmac_f32 v127, v0, v0
    v_add_f32 v126, v126, v15
    v_fmac_f32 v127, v15, v15
    s_waitcnt lgkmcnt(3)
    v_mfma_f32_32x32x16_bf16 v[16:31], v[104:107], v[96:99], v[16:31]
    v_lshlrev_b32 v0, 16, v96
    v_and_b32 v15, 0xffff0000, v96
    v_add_f32 v124, v124, v0
    v_fmac_f32 v125, v0, v0
    v_add_f32 v124, v124, v15
    v_fmac_f32 v125, v15, v15
    v_lshlrev_b32 v0, 16, v97
    v_and_b32 v15, 0xffff0000, v97
    v_add_f32 v124, v124, v0
    v_fmac_f32 v125, v0, v0
    v_add_f32 v124, v124, v15
    v_fmac_f32 v125, v15, v15
    s_waitcnt lgkmcnt(2)
    v_mfma_f32_32x32x16_bf16 v[32:47], v[104:107], v[100:103], v[32:47]
    v_lshlrev_b32 v0, 16, v98
    v_and_b32 v15, 0xffff0000, v98
    v_add_f32 v124, v124, v0
    v_fmac_f32 v125, v0, v0
    v_add_f32 v124, v124, v15
    v_fmac_f32 v125, v15, v15
    v_lshlrev_b32 v0, 16, v99
    v_and_b32 v15, 0xffff0000, v99
    v_add_f32 v124, v124, v0
    v_fmac_f32 v125, v0, v0
    v_add_f32 v124, v124, v15
    v_fmac_f32 v125, v15, v15
    s_waitcnt lgkmcnt(0)
    s_barrier
    ds_read_b128 v[80:83], v6 offset:32768
    ds_read_b64_tr_b16 v[88:89], v8 offset:8192
    ds_read_b64_tr_b16 v[90:91], v8 offset:8704
    v_mfma_f32_32x32x16_bf16 v[48:63], v[108:111], v[96:99], v[48:63]
    ds_read_b128 v[84:87], v6 offset:36864
    v_mfma_f32_32x32x16_bf16 v[64:79], v[108:111], v[100:103], v[64:79]
    ds_read_b64_tr_b16 v[92:93], v9 offset:8192
    v_mfma_f32_16x16x32_bf16 v[116:119], v[108:111], v[120:123], v[116:119]
    ds_read_b64_tr_b16 v[94:95], v9 offset:8704
    s_waitcnt lgkmcnt(3)
    v_mfma_f32_32x32x16_bf16 v[16:31], v[88:91], v[80:83], v[16:31]
    ds_read_b128 v[96:99], v7 offset:32768
    ds_read_b64_tr_b16 v[104:105], v10 offset:8192
    ds_read_b64_tr_b16 v[106:107], v10 offset:8704
    s_waitcnt lgkmcnt(5)
    v_lshlrev_b32 v0, 16, v84
    v_and_b32 v15, 0xffff0000, v84
    v_add_f32 v126, v126, v0
    v_fmac_f32 v127, v0, v0
    v_add_f32 v126, v126, v15
    v_mfma_f32_32x32x16_bf16 v[32:47], v[88:91], v[84:87], v[32:47]
    ds_read_b128 v[100:103], v7 offset:36864
    v_fmac_f32 v127, v15, v15
    v_lshlrev_b32 v0, 16, v85
    v_and_b32 v15, 0xffff0000, v85
    v_add_f32 v126, v126, v0
    v_fmac_f32 v127, v0, v0
    s_waitcnt lgkmcnt(4)
    v_mfma_f32_32x32x16_bf16 v[48:63], v[92:95], v[80:83], v[48:63]
    ds_read_b64_tr_b16 v[108:109], v11 offset:8192
    v_add_f32 v126, v126, v15
    v_fmac_f32 v127, v15, v15
    v_lshlrev_b32 v0, 16, v86
    v_and_b32 v15, 0xffff0000, v86
    v_add_f32 v126, v126, v0
    v_mfma_f32_32x32x16_bf16 v[64:79], v[92:95], v[84:87], v[64:79]
    ds_read_b64_tr_b16 v[110:111], v11 offset:8704
    v_fmac_f32 v127, v0, v0
    v_add_f32 v126, v126, v15
    v_fmac_f32 v127, v15, v15
    v_lshlrev_b32 v0, 16, v87
    v_and_b32 v15, 0xffff0000, v87
    v_mfma_f32_16x16x32_bf16 v[112:115], v[88:91], v[120:123], v[112:115]
    v_add_f32 v126, v126, v0
    v_fmac_f32 v127, v0, v0
    v_add_f32 v126, v126, v15
    v_fmac_f32 v127, v15, v15
    s_waitcnt lgkmcnt(3)
    v_mfma_f32_32x32x16_bf16 v[16:31], v[104:107], v[96:99], v[16:31]
    v_lshlrev_b32 v0, 16, v96
    v_and_b32 v15, 0xffff0000, v96
    v_add_f32 v124, v124, v0
    v_fmac_f32 v125, v0, v0
    v_add_f32 v124, v124, v15
    v_fmac_f32 v125, v15, v15
    v_lshlrev_b32 v0, 16, v97
    v_and_b32 v15, 0xffff0000, v97
    v_add_f32 v124, v124, v0
    v_fmac_f32 v125, v0, v0
    v_add_f32 v124, v124, v15
    v_fmac_f32 v125, v15, v15
    s_waitcnt lgkmcnt(2)
    v_mfma_f32_32x32x16_bf16 v[32:47], v[104:107], v[100:103], v[32:47]
    v_lshlrev_b32 v0, 16, v98
    v_and_b32 v15, 0xffff0000, v98
    v_add_f32 v124, v124, v0
    v_fmac_f32 v125, v0, v0
    v_add_f32 v124, v124, v15
    v_fmac_f32 v125, v15, v15
    v_lshlrev_b32 v0, 16, v99
    v_and_b32 v15, 0xffff0000, v99
    v_add_f32 v124, v124, v0
    v_fmac_f32 v125, v0, v0
    v_add_f32 v124, v124, v15
    v_fmac_f32 v125, v15, v15
    s_waitcnt lgkmcnt(0)
    s_barrier
    ds_read_b128 v[80:83], v4 offset:0
    ds_read_b64_tr_b16 v[88:89], v8 offset:16384
    ds_read_b64_tr_b16 v[90:91], v8 offset:16896
    v_mfma_f32_32x32x16_bf16 v[48:63], v[108:111], v[96:99], v[48:63]
    ds_read_b128 v[84:87], v4 offset:4096
    v_mfma_f32_32x32x16_bf16 v[64:79], v[108:111], v[100:103], v[64:79]
    ds_read_b64_tr_b16 v[92:93], v9 offset:16384
    v_mfma_f32_16x16x32_bf16 v[116:119], v[108:111], v[120:123], v[116:119]
    ds_read_b64_tr_b16 v[94:95], v9 offset:16896
    s_waitcnt lgkmcnt(3)
    v_mfma_f32_32x32x16_bf16 v[16:31], v[88:91], v[80:83], v[16:31]
    ds_read_b128 v[96:99], v5 offset:0
    ds_read_b64_tr_b16 v[104:105], v10 offset:16384
    ds_read_b64_tr_b16 v[106:107], v10 offset:16896
    s_waitcnt lgkmcnt(5)
    v_lshlrev_b32 v0, 16, v84
    v_and_b32 v15, 0xffff0000, v84
    v_add_f32 v126, v126, v0
    v_fmac_f32 v127, v0, v0
    v_add_f32 v126, v126, v15
    v_mfma_f32_32x32x16_bf16 v[32:47], v[88:91], v[84:87], v[32:47]
    ds_read_b128 v[100:103], v5 offset:4096
    v_fmac_f32 v127, v15, v15
    v_lshlrev_b32 v0, 16, v85
    v_and_b32 v15, 0xffff0000, v85
    v_add_f32 v126, v126, v0
    v_fmac_f32 v127, v0, v0
    s_waitcnt lgkmcnt(4)
    v_mfma_f32_32x32x16_bf16 v[48:63], v[92:95], v[80:83], v[48:63]
    ds_read_b64_tr_b16 v[108:109], v11 offset:16384
    v_add_f32 v126, v126, v15
    v_fmac_f32 v127, v15, v15
    v_lshlrev_b32 v0, 16, v86
    v_and_b32 v15, 0xffff0000, v86
    v_add_f32 v126, v126, v0
    v_mfma_f32_32x32x16_bf16 v[64:79], v[92:95], v[84:87], v[64:79]
    ds_read_b64_tr_b16 v[110:111], v11 offset:16896
    v_fmac_f32 v127, v0, v0
    v_add_f32 v126, v126, v15
    v_fmac_f32 v127, v15, v15
    v_lshlrev_b32 v0, 16, v87
    v_and_b32 v15, 0xffff0000, v87
    v_mfma_f32_16x16x32_bf16 v[112:115], v[88:91], v[120:123], v[112:115]
    v_add_f32 v126, v126, v0
    v_fmac_f32 v127, v0, v0
    v_add_f32 v126, v126, v15
    v_fmac_f32 v127, v15, v15
    s_waitcnt lgkmcnt(3)
    v_mfma_f32_32x32x16_bf16 v[16:31], v[104:107], v[96:99], v[16:31]
    v_lshlrev_b32 v0, 16, v96
    v_and_b32 v15, 0xffff0000, v96
    v_add_f32 v124, v124, v0
    v_fmac_f32 v125, v0, v0
    v_add_f32 v124, v124, v15
    v_fmac_f32 v125, v15, v15
    v_lshlrev_b32 v0, 16, v97
    v_and_b32 v15, 0xffff0000, v97
    v_add_f32 v124, v124, v0
    v_fmac_f32 v125, v0, v0
    v_add_f32 v124, v124, v15
    v_fmac_f32 v125, v15, v15
    s_waitcnt lgkmcnt(2)
    v_mfma_f32_32x32x16_bf16 v[32:47], v[104:107], v[100:103], v[32:47]
    v_lshlrev_b32 v0, 16, v98
    v_and_b32 v15, 0xffff0000, v98
    v_add_f32 v124, v124, v0
    v_fmac_f32 v125, v0, v0
    v_add_f32 v124, v124, v15
    v_fmac_f32 v125, v15, v15
    v_lshlrev_b32 v0, 16, v99
    v_and_b32 v15, 0xffff0000, v99
    v_add_f32 v124, v124, v0
    v_fmac_f32 v125, v0, v0
    v_add_f32 v124, v124, v15
    v_fmac_f32 v125, v15, v15
    s_waitcnt lgkmcnt(0)
    s_barrier
    ds_read_b128 v[80:83], v6 offset:0
    ds_read_b64_tr_b16 v[88:89], v8 offset:24576
    ds_read_b64_tr_b16 v[90:91], v8 offset:25088
    v_mfma_f32_32x32x16_bf16 v[48:63], v[108:111], v[96:99], v[48:63]
    ds_read_b128 v[84:87], v6 offset:4096
    v_mfma_f32_32x32x16_bf16 v[64:79], v[108:111], v[100:103], v[64:79]
    ds_read_b64_tr_b16 v[92:93], v9 offset:24576
    v_mfma_f32_16x16x32_bf16 v[116:119], v[108:111], v[120:123], v[116:119]
    ds_read_b64_tr_b16 v[94:95], v9 offset:25088
    s_waitcnt lgkmcnt(3)
    v_mfma_f32_32x32x16_bf16 v[16:31], v[88:91], v[80:83], v[16:31]
    ds_read_b128 v[96:99], v7 offset:0
    ds_read_b64_tr_b16 v[104:105], v10 offset:24576
    ds_read_b64_tr_b16 v[106:107], v10 offset:25088
    s_waitcnt lgkmcnt(5)
    v_lshlrev_b32 v0, 16, v84
    v_and_b32 v15, 0xffff0000, v84
    v_add_f32 v126, v126, v0
    v_fmac_f32 v127, v0, v0
    v_add_f32 v126, v126, v15
    v_mfma_f32_32x32x16_bf16 v[32:47], v[88:91], v[84:87], v[32:47]
    ds_read_b128 v[100:103], v7 offset:4096
    v_fmac_f32 v127, v15, v15
    v_lshlrev_b32 v0, 16, v85
    v_and_b32 v15, 0xffff0000, v85
    v_add_f32 v126, v126, v0
    v_fmac_f32 v127, v0, v0
    s_waitcnt lgkmcnt(4)
    v_mfma_f32_32x32x16_bf16 v[48:63], v[92:95], v[80:83], v[48:63]
    ds_read_b64_tr_b16 v[108:109], v11 offset:24576
    v_add_f32 v126, v126, v15
    v_fmac_f32 v127, v15, v15
    v_lshlrev_b32 v0, 16, v86
    v_and_b32 v15, 0xffff0000, v86
    v_add_f32 v126, v126, v0
    v_mfma_f32_32x32x16_bf16 v[64:79], v[92:95], v[84:87], v[64:79]
    ds_read_b64_tr_b16 v[110:111], v11 offset:25088
    v_fmac_f32 v127, v0, v0
    v_add_f32 v126, v126, v15
    v_fmac_f32 v127, v15, v15
    v_lshlrev_b32 v0, 16, v87
    v_and_b32 v15, 0xffff0000, v87
    v_mfma_f32_16x16x32_bf16 v[112:115], v[88:91], v[120:123], v[112:115]
    v_add_f32 v126, v126, v0
    v_fmac_f32 v127, v0, v0
    v_add_f32 v126, v126, v15
    v_fmac_f32 v127, v15, v15
    s_waitcnt lgkmcnt(3)
    v_mfma_f32_32x32x16_bf16 v[16:31], v[104:107], v[96:99], v[16:31]
    v_lshlrev_b32 v0, 16, v96
    v_and_b32 v15, 0xffff0000, v96
    v_add_f32 v124, v124, v0
    v_fmac_f32 v125, v0, v0
    v_add_f32 v124, v124, v15
    v_fmac_f32 v125, v15, v15
    v_lshlrev_b32 v0, 16, v97
    v_and_b32 v15, 0xffff0000, v97
    v_add_f32 v124, v124, v0
    v_fmac_f32 v125, v0, v0
    v_add_f32 v124, v124, v15
    v_fmac_f32 v125, v15, v15
    s_waitcnt lgkmcnt(2)
    v_mfma_f32_32x32x16_bf16 v[32:47], v[104:107], v[100:103], v[32:47]
    v_lshlrev_b32 v0, 16, v98
    v_and_b32 v15, 0xffff0000, v98
    v_add_f32 v124, v124, v0
    v_fmac_f32 v125, v0, v0
    v_add_f32 v124, v124, v15
    v_fmac_f32 v125, v15, v15
    v_lshlrev_b32 v0, 16, v99
    v_and_b32 v15, 0xffff0000, v99
    v_add_f32 v124, v124, v0
    v_fmac_f32 v125, v0, v0
    v_add_f32 v124, v124, v15
    v_fmac_f32 v125, v15, v15
    s_waitcnt lgkmcnt(0)
    s_barrier
    ds_read_b128 v[80:83], v4 offset:16384
    ds_read_b64_tr_b16 v[88:89], v8 offset:0
    ds_read_b64_tr_b16 v[90:91], v8 offset:512
    v_mfma_f32_32x32x16_bf16 v[48:63], v[108:111], v[96:99], v[48:63]
    ds_read_b128 v[84:87], v4 offset:20480
    v_mfma_f32_32x32x16_bf16 v[64:79], v[108:111], v[100:103], v[64:79]
    ds_read_b64_tr_b16 v[92:93], v9 offset:0
    v_mfma_f32_16x16x32_bf16 v[116:119], v[108:111], v[120:123], v[116:119]
    ds_read_b64_tr_b16 v[94:95], v9 offset:512
    s_waitcnt lgkmcnt(3)
    v_mfma_f32_32x32x16_bf16 v[16:31], v[88:91], v[80:83], v[16:31]
    ds_read_b128 v[96:99], v5 offset:16384
    ds_read_b64_tr_b16 v[104:105], v10 offset:0
    ds_read_b64_tr_b16 v[106:107], v10 offset:512
    s_waitcnt lgkmcnt(5)
    v_lshlrev_b32 v0, 16, v84
    v_and_b32 v15, 0xffff0000, v84
    v_add_f32 v126, v126, v0
    v_fmac_f32 v127, v0, v0
    v_add_f32 v126, v126, v15
    v_mfma_f32_32x32x16_bf16 v[32:47], v[88:91], v[84:87], v[32:47]
    ds_read_b128 v[100:103], v5 offset:20480
    v_fmac_f32 v127, v15, v15
    v_lshlrev_b32 v0, 16, v85
    v_and_b32 v15, 0xffff0000, v85
    v_add_f32 v126, v126, v0
    v_fmac_f32 v127, v0, v0
    s_waitcnt lgkmcnt(4)
    v_mfma_f32_32x32x16_bf16 v[48:63], v[92:95], v[80:83], v[48:63]
    ds_read_b64_tr_b16 v[108:109], v11 offset:0
    v_add_f32 v126, v126, v15
    v_fmac_f32 v127, v15, v15
    v_lshlrev_b32 v0, 16, v86
    v_and_b32 v15, 0xffff0000, v86
    v_add_f32 v126, v126, v0
    v_mfma_f32_32x32x16_bf16 v[64:79], v[92:95], v[84:87], v[64:79]
    ds_read_b64_tr_b16 v[110:111], v11 offset:512
    v_fmac_f32 v127, v0, v0
    v_add_f32 v126, v126, v15
    v_fmac_f32 v127, v15, v15
    v_lshlrev_b32 v0, 16, v87
    v_and_b32 v15, 0xffff0000, v87
    v_mfma_f32_16x16x32_bf16 v[112:115], v[88:91], v[120:123], v[112:115]
    v_add_f32 v126, v126, v0
    v_fmac_f32 v127, v0, v0
    v_add_f32 v126, v126, v15
    v_fmac_f32 v127, v15, v15
    s_waitcnt lgkmcnt(3)
    v_mfma_f32_32x32x16_bf16 v[16:31], v[104:107], v[96:99], v[16:31]
    v_lshlrev_b32 v0, 16, v96
    v_and_b32 v15, 0xffff0000, v96
    v_add_f32 v124, v124, v0
    v_fmac_f32 v125, v0, v0
    v_add_f32 v124, v124, v15
    v_fmac_f32 v125, v15, v15
    v_lshlrev_b32 v0, 16, v97
    v_and_b32 v15, 0xffff0000, v97
    v_add_f32 v124, v124, v0
    v_fmac_f32 v125, v0, v0
    v_add_f32 v124, v124, v15
    v_fmac_f32 v125, v15, v15
    s_waitcnt lgkmcnt(2)
    v_mfma_f32_32x32x16_bf16 v[32:47], v[104:107], v[100:103], v[32:47]
    v_lshlrev_b32 v0, 16, v98
    v_and_b32 v15, 0xffff0000, v98
    v_add_f32 v124, v124, v0
    v_fmac_f32 v125, v0, v0
    v_add_f32 v124, v124, v15
    v_fmac_f32 v125, v15, v15
    v_lshlrev_b32 v0, 16, v99
    v_and_b32 v15, 0xffff0000, v99
    v_add_f32 v124, v124, v0
    v_fmac_f32 v125, v0, v0
    v_add_f32 v124, v124, v15
    v_fmac_f32 v125, v15, v15
    s_waitcnt lgkmcnt(0)
    s_barrier
    ds_read_b128 v[80:83], v6 offset:16384
    ds_read_b64_tr_b16 v[88:89], v8 offset:8192
    ds_read_b64_tr_b16 v[90:91], v8 offset:8704
    v_mfma_f32_32x32x16_bf16 v[48:63], v[108:111], v[96:99], v[48:63]
    ds_read_b128 v[84:87], v6 offset:20480
    v_mfma_f32_32x32x16_bf16 v[64:79], v[108:111], v[100:103], v[64:79]
    ds_read_b64_tr_b16 v[92:93], v9 offset:8192
    v_mfma_f32_16x16x32_bf16 v[116:119], v[108:111], v[120:123], v[116:119]
    ds_read_b64_tr_b16 v[94:95], v9 offset:8704
    s_waitcnt lgkmcnt(3)
    v_mfma_f32_32x32x16_bf16 v[16:31], v[88:91], v[80:83], v[16:31]
    ds_read_b128 v[96:99], v7 offset:16384
    ds_read_b64_tr_b16 v[104:105], v10 offset:8192
    ds_read_b64_tr_b16 v[106:107], v10 offset:8704
    s_waitcnt lgkmcnt(5)
    v_lshlrev_b32 v0, 16, v84
    v_and_b32 v15, 0xffff0000, v84
    v_add_f32 v126, v126, v0
    v_fmac_f32 v127, v0, v0
    v_add_f32 v126, v126, v15
    v_mfma_f32_32x32x16_bf16 v[32:47], v[88:91], v[84:87], v[32:47]
    ds_read_b128 v[100:103], v7 offset:20480
    v_fmac_f32 v127, v15, v15
    v_lshlrev_b32 v0, 16, v85
    v_and_b32 v15, 0xffff0000, v85
    v_add_f32 v126, v126, v0
    v_fmac_f32 v127, v0, v0
    s_waitcnt lgkmcnt(4)
    v_mfma_f32_32x32x16_bf16 v[48:63], v[92:95], v[80:83], v[48:63]
    ds_read_b64_tr_b16 v[108:109], v11 offset:8192
    v_add_f32 v126, v126, v15
    v_fmac_f32 v127, v15, v15
    v_lshlrev_b32 v0, 16, v86
    v_and_b32 v15, 0xffff0000, v86
    v_add_f32 v126, v126, v0
    v_mfma_f32_32x32x16_bf16 v[64:79], v[92:95], v[84:87], v[64:79]
    ds_read_b64_tr_b16 v[110:111], v11 offset:8704
    v_fmac_f32 v127, v0, v0
    v_add_f32 v126, v126, v15
    v_fmac_f32 v127, v15, v15
    v_lshlrev_b32 v0, 16, v87
    v_and_b32 v15, 0xffff0000, v87
    v_mfma_f32_16x16x32_bf16 v[112:115], v[88:91], v[120:123], v[112:115]
    v_add_f32 v126, v126, v0
    v_fmac_f32 v127, v0, v0
    v_add_f32 v126, v126, v15
    v_fmac_f32 v127, v15, v15
    s_waitcnt lgkmcnt(3)
    v_mfma_f32_32x32x16_bf16 v[16:31], v[104:107], v[96:99], v[16:31]
    v_lshlrev_b32 v0, 16, v96
    v_and_b32 v15, 0xffff0000, v96
    v_add_f32 v124, v124, v0
    v_fmac_f32 v125, v0, v0
    v_add_f32 v124, v124, v15
    v_fmac_f32 v125, v15, v15
    v_lshlrev_b32 v0, 16, v97
    v_and_b32 v15, 0xffff0000, v97
    v_add_f32 v124, v124, v0
    v_fmac_f32 v125, v0, v0
    v_add_f32 v124, v124, v15
    v_fmac_f32 v125, v15, v15
    s_waitcnt lgkmcnt(2)
    v_mfma_f32_32x32x16_bf16 v[32:47], v[104:107], v[100:103], v[32:47]
    v_lshlrev_b32 v0, 16, v98
    v_and_b32 v15, 0xffff0000, v98
    v_add_f32 v124, v124, v0
    v_fmac_f32 v125, v0, v0
    v_add_f32 v124, v124, v15
    v_fmac_f32 v125, v15, v15
    v_lshlrev_b32 v0, 16, v99
    v_and_b32 v15, 0xffff0000, v99
    v_add_f32 v124, v124, v0
    v_fmac_f32 v125, v0, v0
    v_add_f32 v124, v124, v15
    v_fmac_f32 v125, v15, v15
    s_waitcnt lgkmcnt(0)
    s_barrier
    ds_read_b128 v[80:83], v4 offset:32768
    ds_read_b64_tr_b16 v[88:89], v8 offset:16384
    ds_read_b64_tr_b16 v[90:91], v8 offset:16896
    v_mfma_f32_32x32x16_bf16 v[48:63], v[108:111], v[96:99], v[48:63]
    ds_read_b128 v[84:87], v4 offset:36864
    v_mfma_f32_32x32x16_bf16 v[64:79], v[108:111], v[100:103], v[64:79]
    ds_read_b64_tr_b16 v[92:93], v9 offset:16384
    v_mfma_f32_16x16x32_bf16 v[116:119], v[108:111], v[120:123], v[116:119]
    ds_read_b64_tr_b16 v[94:95], v9 offset:16896
    s_waitcnt lgkmcnt(3)
    v_mfma_f32_32x32x16_bf16 v[16:31], v[88:91], v[80:83], v[16:31]
    ds_read_b128 v[96:99], v5 offset:32768
    ds_read_b64_tr_b16 v[104:105], v10 offset:16384
    ds_read_b64_tr_b16 v[106:107], v10 offset:16896
    s_waitcnt lgkmcnt(5)
    v_lshlrev_b32 v0, 16, v84
    v_and_b32 v15, 0xffff0000, v84
    v_add_f32 v126, v126, v0
    v_fmac_f32 v127, v0, v0
    v_add_f32 v126, v126, v15
    v_mfma_f32_32x32x16_bf16 v[32:47], v[88:91], v[84:87], v[32:47]
    ds_read_b128 v[100:103], v5 offset:36864
    v_fmac_f32 v127, v15, v15
    v_lshlrev_b32 v0, 16, v85
    v_and_b32 v15, 0xffff0000, v85
    v_add_f32 v126, v126, v0
    v_fmac_f32 v127, v0, v0
    s_waitcnt lgkmcnt(4)
    v_mfma_f32_32x32x16_bf16 v[48:63], v[92:95], v[80:83], v[48:63]
    ds_read_b64_tr_b16 v[108:109], v11 offset:16384
    v_add_f32 v126, v126, v15
    v_fmac_f32 v127, v15, v15
    v_lshlrev_b32 v0, 16, v86
    v_and_b32 v15, 0xffff0000, v86
    v_add_f32 v126, v126, v0
    v_mfma_f32_32x32x16_bf16 v[64:79], v[92:95], v[84:87], v[64:79]
    ds_read_b64_tr_b16 v[110:111], v11 offset:16896
    v_fmac_f32 v127, v0, v0
    v_add_f32 v126, v126, v15
    v_fmac_f32 v127, v15, v15
    v_lshlrev_b32 v0, 16, v87
    v_and_b32 v15, 0xffff0000, v87
    v_mfma_f32_16x16x32_bf16 v[112:115], v[88:91], v[120:123], v[112:115]
    v_add_f32 v126, v126, v0
    v_fmac_f32 v127, v0, v0
    v_add_f32 v126, v126, v15
    v_fmac_f32 v127, v15, v15
    s_waitcnt lgkmcnt(3)
    v_mfma_f32_32x32x16_bf16 v[16:31], v[104:107], v[96:99], v[16:31]
    v_lshlrev_b32 v0, 16, v96
    v_and_b32 v15, 0xffff0000, v96
    v_add_f32 v124, v124, v0
    v_fmac_f32 v125, v0, v0
    v_add_f32 v124, v124, v15
    v_fmac_f32 v125, v15, v15
    v_lshlrev_b32 v0, 16, v97
    v_and_b32 v15, 0xffff0000, v97
    v_add_f32 v124, v124, v0
    v_fmac_f32 v125, v0, v0
    v_add_f32 v124, v124, v15
    v_fmac_f32 v125, v15, v15
    s_waitcnt lgkmcnt(2)
    v_mfma_f32_32x32x16_bf16 v[32:47], v[104:107], v[100:103], v[32:47]
    v_lshlrev_b32 v0, 16, v98
    v_and_b32 v15, 0xffff0000, v98
    v_add_f32 v124, v124, v0
    v_fmac_f32 v125, v0, v0
    v_add_f32 v124, v124, v15
    v_fmac_f32 v125, v15, v15
    v_lshlrev_b32 v0, 16, v99
    v_and_b32 v15, 0xffff0000, v99
    v_add_f32 v124, v124, v0
    v_fmac_f32 v125, v0, v0
    v_add_f32 v124, v124, v15
    v_fmac_f32 v125, v15, v15
    s_waitcnt lgkmcnt(0)
    s_barrier
    ds_read_b128 v[80:83], v6 offset:32768
    ds_read_b64_tr_b16 v[88:89], v8 offset:24576
    ds_read_b64_tr_b16 v[90:91], v8 offset:25088
    v_mfma_f32_32x32x16_bf16 v[48:63], v[108:111], v[96:99], v[48:63]
    ds_read_b128 v[84:87], v6 offset:36864
    v_mfma_f32_32x32x16_bf16 v[64:79], v[108:111], v[100:103], v[64:79]
    ds_read_b64_tr_b16 v[92:93], v9 offset:24576
    v_mfma_f32_16x16x32_bf16 v[116:119], v[108:111], v[120:123], v[116:119]
    ds_read_b64_tr_b16 v[94:95], v9 offset:25088
    s_waitcnt lgkmcnt(3)
    v_mfma_f32_32x32x16_bf16 v[16:31], v[88:91], v[80:83], v[16:31]
    ds_read_b128 v[96:99], v7 offset:32768
    ds_read_b64_tr_b16 v[104:105], v10 offset:24576
    ds_read_b64_tr_b16 v[106:107], v10 offset:25088
    s_waitcnt lgkmcnt(5)
    v_lshlrev_b32 v0, 16, v84
    v_and_b32 v15, 0xffff0000, v84
    v_add_f32 v126, v126, v0
    v_fmac_f32 v127, v0, v0
    v_add_f32 v126, v126, v15
    v_mfma_f32_32x32x16_bf16 v[32:47], v[88:91], v[84:87], v[32:47]
    ds_read_b128 v[100:103], v7 offset:36864
    v_fmac_f32 v127, v15, v15
    v_lshlrev_b32 v0, 16, v85
    v_and_b32 v15, 0xffff0000, v85
    v_add_f32 v126, v126, v0
    v_fmac_f32 v127, v0, v0
    s_waitcnt lgkmcnt(4)
    v_mfma_f32_32x32x16_bf16 v[48:63], v[92:95], v[80:83], v[48:63]
    ds_read_b64_tr_b16 v[108:109], v11 offset:24576
    v_add_f32 v126, v126, v15
    v_fmac_f32 v127, v15, v15
    v_lshlrev_b32 v0, 16, v86
    v_and_b32 v15, 0xffff0000, v86
    v_add_f32 v126, v126, v0
    v_mfma_f32_32x32x16_bf16 v[64:79], v[92:95], v[84:87], v[64:79]
    ds_read_b64_tr_b16 v[110:111], v11 offset:25088
    v_fmac_f32 v127, v0, v0
    v_add_f32 v126, v126, v15
    v_fmac_f32 v127, v15, v15
    v_lshlrev_b32 v0, 16, v87
    v_and_b32 v15, 0xffff0000, v87
    v_mfma_f32_16x16x32_bf16 v[112:115], v[88:91], v[120:123], v[112:115]
    v_add_f32 v126, v126, v0
    v_fmac_f32 v127, v0, v0
    v_add_f32 v126, v126, v15
    v_fmac_f32 v127, v15, v15
    s_waitcnt lgkmcnt(3)
    v_mfma_f32_32x32x16_bf16 v[16:31], v[104:107], v[96:99], v[16:31]
    v_lshlrev_b32 v0, 16, v96
    v_and_b32 v15, 0xffff0000, v96
    v_add_f32 v124, v124, v0
    v_fmac_f32 v125, v0, v0
    v_add_f32 v124, v124, v15
    v_fmac_f32 v125, v15, v15
    v_lshlrev_b32 v0, 16, v97
    v_and_b32 v15, 0xffff0000, v97
    v_add_f32 v124, v124, v0
    v_fmac_f32 v125, v0, v0
    v_add_f32 v124, v124, v15
    v_fmac_f32 v125, v15, v15
    s_waitcnt lgkmcnt(2)
    v_mfma_f32_32x32x16_bf16 v[32:47], v[104:107], v[100:103], v[32:47]
    v_lshlrev_b32 v0, 16, v98
    v_and_b32 v15, 0xffff0000, v98
    v_add_f32 v124, v124, v0
    v_fmac_f32 v125, v0, v0
    v_add_f32 v124, v124, v15
    v_fmac_f32 v125, v15, v15
    v_lshlrev_b32 v0, 16, v99
    v_and_b32 v15, 0xffff0000, v99
    v_add_f32 v124, v124, v0
    v_fmac_f32 v125, v0, v0
    v_add_f32 v124, v124, v15
    v_fmac_f32 v125, v15, v15
    s_waitcnt lgkmcnt(0)
    s_barrier
    ds_read_b128 v[80:83], v4 offset:0
    ds_read_b64_tr_b16 v[88:89], v8 offset:0
    ds_read_b64_tr_b16 v[90:91], v8 offset:512
    v_mfma_f32_32x32x16_bf16 v[48:63], v[108:111], v[96:99], v[48:63]
    ds_read_b128 v[84:87], v4 offset:4096
    v_mfma_f32_32x32x16_bf16 v[64:79], v[108:111], v[100:103], v[64:79]
    ds_read_b64_tr_b16 v[92:93], v9 offset:0
    v_mfma_f32_16x16x32_bf16 v[116:119], v[108:111], v[120:123], v[116:119]
    ds_read_b64_tr_b16 v[94:95], v9 offset:512
    s_branch B1_C_LOOP
B1_C_DONE:
    s_waitcnt vmcnt(0)
    s_lshr_b32 s54, s44, 1
    s_and_b32 s55, s44, 1
    s_mul_i32 s56, s54, 2048
    s_add_u32 s56, s56, 65536
    s_lshl_b32 s57, s55, 4
    s_mul_i32 s55, s55, 512
    s_add_u32 s55, s55, 69632
    s_lshl_b32 s54, s54, 7
    s_add_u32 s54, s54, s55
    v_and_b32 v120, 31, v1
    v_lshlrev_b32 v120, 5, v120
    v_add_u32 v120, s56, v120
    v_lshrrev_b32 v122, 5, v1
    v_lshl_add_u32 v122, v122, 3, v120
    v_add_u32 v122, s57, v122
    ds_write_b64 v122, v[124:125] offset:0
    ds_write_b64 v122, v[126:127] offset:1024
    v_and_b32 v121, 1, v1
    v_lshlrev_b32 v121, 6, v121
    v_and_b32 v122, 48, v1
    v_add3_u32 v121, v121, v122, s54
    s_mov_b32 exec_lo, 0x30003
    s_mov_b32 exec_hi, 0x30003
    ds_write_b128 v121, v[112:115] offset:0
    ds_write_b128 v121, v[116:119] offset:256
    s_mov_b64 exec, -1
    s_waitcnt lgkmcnt(0)
    v_lshlrev_b32 v121, 2, v1
    v_add_u32 v121, s55, v121
    s_barrier
    ds_read_b128 v[96:99], v120 offset:0
    ds_read_b128 v[100:103], v120 offset:16
    ds_read_b128 v[104:107], v120 offset:1024
    ds_read_b128 v[108:111], v120 offset:1040
    ds_read_b32 v112, v121 offset:0
    ds_read_b32 v113, v121 offset:256
    v_mov_b32 v82, 0
    v_mov_b32 v83, 0
    v_mov_b32 v86, 0
    v_mov_b32 v87, 0
    v_mov_b32 v90, 0
    v_mov_b32 v91, 0
    v_mov_b32 v94, 0
    v_mov_b32 v95, 0
    s_waitcnt lgkmcnt(0)
    v_add_f32 v96, v96, v98
    v_add_f32 v104, v104, v106
    v_cvt_pk_bf16_f32 v114, v112, v112
    v_cvt_pk_bf16_f32 v117, v113, v113
    v_add_f32 v100, v100, v102
    v_add_f32 v108, v108, v110
    v_lshlrev_b32 v114, 16, v114
    v_lshlrev_b32 v117, 16, v117
    v_add_f32 v96, v96, v100
    v_add_f32 v104, v104, v108
    v_sub_f32 v115, v112, v114
    v_sub_f32 v118, v113, v117
    v_mul_f32 v96, 0x3b000000, v96
    v_mul_f32 v104, 0x3b000000, v104
    v_cvt_pk_bf16_f32 v88, v114, v115
    v_cvt_pk_bf16_f32 v92, v117, v118
    v_cvt_pk_bf16_f32 v80, -v96, -v96
    v_cvt_pk_bf16_f32 v84, -v104, -v104
    v_and_b32 v116, 0xffff0000, v88
    v_and_b32 v119, 0xffff0000, v92
    v_cvt_pk_bf16_f32 v81, -v96, -v96
    v_cvt_pk_bf16_f32 v85, -v104, -v104
    v_sub_f32 v115, v115, v116
    v_sub_f32 v118, v118, v119
    v_cvt_pk_bf16_f32 v89, v115, 0
    v_cvt_pk_bf16_f32 v93, v118, 0
    s_nop 0
    v_mfma_f32_32x32x16_bf16 v[16:31], v[88:91], v[80:83], v[16:31]
    v_mfma_f32_32x32x16_bf16 v[32:47], v[88:91], v[84:87], v[32:47]
    v_mfma_f32_32x32x16_bf16 v[48:63], v[92:95], v[80:83], v[48:63]
    v_mfma_f32_32x32x16_bf16 v[64:79], v[92:95], v[84:87], v[64:79]
    v_add_f32 v97, v97, v99
    v_add_f32 v105, v105, v107
    v_add_f32 v101, v101, v103
    v_add_f32 v109, v109, v111
    v_add_f32 v97, v97, v101
    v_add_f32 v105, v105, v109
    v_mul_f32 v97, 0x3b000000, v97
    v_mul_f32 v105, 0x3b000000, v105
    v_fma_f32 v97, -v96, v96, v97
    v_fma_f32 v105, -v104, v104, v105
    v_max_f32 v97, 0, v97
    v_max_f32 v105, 0, v105
    v_cvt_pk_bf16_f32 v97, v97, v97
    v_cvt_pk_bf16_f32 v105, v105, v105
    v_lshlrev_b32 v97, 16, v97
    v_lshlrev_b32 v105, 16, v105
    v_add_f32 v97, 0x3727c5ac, v97
    v_add_f32 v105, 0x3727c5ac, v105
    v_cvt_pk_bf16_f32 v97, v97, v97
    v_cvt_pk_bf16_f32 v105, v105, v105
    v_lshlrev_b32 v97, 16, v97
    v_lshlrev_b32 v105, 16, v105
    v_sqrt_f32 v97, v97
    v_sqrt_f32 v105, v105
    v_cvt_pk_bf16_f32 v97, v97, v97
    v_cvt_pk_bf16_f32 v105, v105, v105
    v_lshlrev_b32 v97, 16, v97
    v_lshlrev_b32 v105, 16, v105
    v_rcp_f32 v4, v97
    v_rcp_f32 v5, v105
    s_mov_b32 s56, 0xbdd2d3e8
    s_mov_b32 s57, 0xbdd2d3e8
    v_mov_b32 v120, 0xc0135761
    v_mov_b32 v121, 0xc0135761
    s_lshr_b32 s54, s44, 1
    s_lshl_b32 s54, s54, 6
    v_and_b32 v122, 31, v1
    v_add_u32 v122, s54, v122
    s_lshl_b32 s55, s45, 7
    v_add_u32 v123, s55, v122
    v_lshrrev_b32 v124, 5, v1
    v_lshlrev_b32 v123, 5, v123
    v_lshl_add_u32 v123, v124, 4, v123
    v_mul_f32 v48, v48, v4
    v_mul_f32 v49, v49, v4
    v_mul_f32 v50, v50, v4
    v_mul_f32 v51, v51, v4
    v_mul_f32 v52, v52, v4
    v_mul_f32 v53, v53, v4
    v_mul_f32 v54, v54, v4
    v_mul_f32 v55, v55, v4
    v_cvt_pk_bf16_f32 v96, v48, v49
    v_cvt_pk_bf16_f32 v97, v50, v51
    v_cvt_pk_bf16_f32 v98, v52, v53
    v_cvt_pk_bf16_f32 v99, v54, v55
    v_lshlrev_b32 v48, 16, v96
    v_and_b32 v49, 0xffff0000, v96
    v_lshlrev_b32 v50, 16, v97
    v_and_b32 v51, 0xffff0000, v97
    v_lshlrev_b32 v52, 16, v98
    v_and_b32 v53, 0xffff0000, v98
    v_lshlrev_b32 v54, 16, v99
    v_and_b32 v55, 0xffff0000, v99
    v_mul_f32 v112, v48, v48
    v_mul_f32 v113, v49, v49
    v_mul_f32 v114, v50, v50
    v_mul_f32 v115, v51, v51
    v_mul_f32 v116, v52, v52
    v_mul_f32 v117, v53, v53
    v_mul_f32 v118, v54, v54
    v_mul_f32 v119, v55, v55
    v_fma_f32 v112, v112, s56, v120
    v_fma_f32 v113, v113, s57, v121
    v_fma_f32 v114, v114, s56, v120
    v_fma_f32 v115, v115, s57, v121
    v_fma_f32 v116, v116, s56, v120
    v_fma_f32 v117, v117, s57, v121
    v_fma_f32 v118, v118, s56, v120
    v_fma_f32 v119, v119, s57, v121
    v_mul_f32 v112, v112, v48
    v_mul_f32 v113, v113, v49
    v_mul_f32 v114, v114, v50
    v_mul_f32 v115, v115, v51
    v_mul_f32 v116, v116, v52
    v_mul_f32 v117, v117, v53
    v_mul_f32 v118, v118, v54
    v_mul_f32 v119, v119, v55
    v_exp_f32 v112, v112
    v_exp_f32 v113, v113
    v_exp_f32 v114, v114
    v_exp_f32 v115, v115
    v_exp_f32 v116, v116
    v_exp_f32 v117, v117
    v_exp_f32 v118, v118
    v_exp_f32 v119, v119
    v_add_f32 v112, 1.0, v112
    v_add_f32 v113, 1.0, v113
    v_add_f32 v114, 1.0, v114
    v_add_f32 v115, 1.0, v115
    v_add_f32 v116, 1.0, v116
    v_add_f32 v117, 1.0, v117
    v_add_f32 v118, 1.0, v118
    v_add_f32 v119, 1.0, v119
    v_rcp_f32 v112, v112
    v_rcp_f32 v113, v113
    v_rcp_f32 v114, v114
    v_rcp_f32 v115, v115
    v_rcp_f32 v116, v116
    v_rcp_f32 v117, v117
    v_rcp_f32 v118, v118
    v_rcp_f32 v119, v119
    v_mul_f32 v112, v112, v48
    v_mul_f32 v113, v113, v49
    v_mul_f32 v114, v114, v50
    v_mul_f32 v115, v115, v51
    v_mul_f32 v116, v116, v52
    v_mul_f32 v117, v117, v53
    v_mul_f32 v118, v118, v54
    v_mul_f32 v119, v119, v55
    v_cvt_pk_bf16_f32 v96, v112, v113
    v_cvt_pk_bf16_f32 v97, v114, v115
    v_cvt_pk_bf16_f32 v98, v116, v117
    v_cvt_pk_bf16_f32 v99, v118, v119
    v_mul_f32 v56, v56, v4
    v_mul_f32 v57, v57, v4
    v_mul_f32 v58, v58, v4
    v_mul_f32 v59, v59, v4
    v_mul_f32 v60, v60, v4
    v_mul_f32 v61, v61, v4
    v_mul_f32 v62, v62, v4
    v_mul_f32 v63, v63, v4
    v_cvt_pk_bf16_f32 v100, v56, v57
    v_cvt_pk_bf16_f32 v101, v58, v59
    v_cvt_pk_bf16_f32 v102, v60, v61
    v_cvt_pk_bf16_f32 v103, v62, v63
    v_lshlrev_b32 v56, 16, v100
    v_and_b32 v57, 0xffff0000, v100
    v_lshlrev_b32 v58, 16, v101
    v_and_b32 v59, 0xffff0000, v101
    v_lshlrev_b32 v60, 16, v102
    v_and_b32 v61, 0xffff0000, v102
    v_lshlrev_b32 v62, 16, v103
    v_and_b32 v63, 0xffff0000, v103
    v_mul_f32 v112, v56, v56
    v_mul_f32 v113, v57, v57
    v_mul_f32 v114, v58, v58
    v_mul_f32 v115, v59, v59
    v_mul_f32 v116, v60, v60
    v_mul_f32 v117, v61, v61
    v_mul_f32 v118, v62, v62
    v_mul_f32 v119, v63, v63
    v_fma_f32 v112, v112, s56, v120
    v_fma_f32 v113, v113, s57, v121
    v_fma_f32 v114, v114, s56, v120
    v_fma_f32 v115, v115, s57, v121
    v_fma_f32 v116, v116, s56, v120
    v_fma_f32 v117, v117, s57, v121
    v_fma_f32 v118, v118, s56, v120
    v_fma_f32 v119, v119, s57, v121
    v_mul_f32 v112, v112, v56
    v_mul_f32 v113, v113, v57
    v_mul_f32 v114, v114, v58
    v_mul_f32 v115, v115, v59
    v_mul_f32 v116, v116, v60
    v_mul_f32 v117, v117, v61
    v_mul_f32 v118, v118, v62
    v_mul_f32 v119, v119, v63
    v_exp_f32 v112, v112
    v_exp_f32 v113, v113
    v_exp_f32 v114, v114
    v_exp_f32 v115, v115
    v_exp_f32 v116, v116
    v_exp_f32 v117, v117
    v_exp_f32 v118, v118
    v_exp_f32 v119, v119
    v_add_f32 v112, 1.0, v112
    v_add_f32 v113, 1.0, v113
    v_add_f32 v114, 1.0, v114
    v_add_f32 v115, 1.0, v115
    v_add_f32 v116, 1.0, v116
    v_add_f32 v117, 1.0, v117
    v_add_f32 v118, 1.0, v118
    v_add_f32 v119, 1.0, v119
    v_rcp_f32 v112, v112
    v_rcp_f32 v113, v113
    v_rcp_f32 v114, v114
    v_rcp_f32 v115, v115
    v_rcp_f32 v116, v116
    v_rcp_f32 v117, v117
    v_rcp_f32 v118, v118
    v_rcp_f32 v119, v119
    v_mul_f32 v112, v112, v56
    v_mul_f32 v113, v113, v57
    v_mul_f32 v114, v114, v58
    v_mul_f32 v115, v115, v59
    v_mul_f32 v116, v116, v60
    v_mul_f32 v117, v117, v61
    v_mul_f32 v118, v118, v62
    v_mul_f32 v119, v119, v63
    v_cvt_pk_bf16_f32 v100, v112, v113
    v_cvt_pk_bf16_f32 v101, v114, v115
    v_cvt_pk_bf16_f32 v102, v116, v117
    v_cvt_pk_bf16_f32 v103, v118, v119
    v_mul_f32 v64, v64, v5
    v_mul_f32 v65, v65, v5
    v_mul_f32 v66, v66, v5
    v_mul_f32 v67, v67, v5
    v_mul_f32 v68, v68, v5
    v_mul_f32 v69, v69, v5
    v_mul_f32 v70, v70, v5
    v_mul_f32 v71, v71, v5
    v_cvt_pk_bf16_f32 v104, v64, v65
    v_cvt_pk_bf16_f32 v105, v66, v67
    v_cvt_pk_bf16_f32 v106, v68, v69
    v_cvt_pk_bf16_f32 v107, v70, v71
    v_lshlrev_b32 v64, 16, v104
    v_and_b32 v65, 0xffff0000, v104
    v_lshlrev_b32 v66, 16, v105
    v_and_b32 v67, 0xffff0000, v105
    v_lshlrev_b32 v68, 16, v106
    v_and_b32 v69, 0xffff0000, v106
    v_lshlrev_b32 v70, 16, v107
    v_and_b32 v71, 0xffff0000, v107
    v_mul_f32 v112, v64, v64
    v_mul_f32 v113, v65, v65
    v_mul_f32 v114, v66, v66
    v_mul_f32 v115, v67, v67
    v_mul_f32 v116, v68, v68
    v_mul_f32 v117, v69, v69
    v_mul_f32 v118, v70, v70
    v_mul_f32 v119, v71, v71
    v_fma_f32 v112, v112, s56, v120
    v_fma_f32 v113, v113, s57, v121
    v_fma_f32 v114, v114, s56, v120
    v_fma_f32 v115, v115, s57, v121
    v_fma_f32 v116, v116, s56, v120
    v_fma_f32 v117, v117, s57, v121
    v_fma_f32 v118, v118, s56, v120
    v_fma_f32 v119, v119, s57, v121
    v_mul_f32 v112, v112, v64
    v_mul_f32 v113, v113, v65
    v_mul_f32 v114, v114, v66
    v_mul_f32 v115, v115, v67
    v_mul_f32 v116, v116, v68
    v_mul_f32 v117, v117, v69
    v_mul_f32 v118, v118, v70
    v_mul_f32 v119, v119, v71
    v_exp_f32 v112, v112
    v_exp_f32 v113, v113
    v_exp_f32 v114, v114
    v_exp_f32 v115, v115
    v_exp_f32 v116, v116
    v_exp_f32 v117, v117
    v_exp_f32 v118, v118
    v_exp_f32 v119, v119
    v_add_f32 v112, 1.0, v112
    v_add_f32 v113, 1.0, v113
    v_add_f32 v114, 1.0, v114
    v_add_f32 v115, 1.0, v115
    v_add_f32 v116, 1.0, v116
    v_add_f32 v117, 1.0, v117
    v_add_f32 v118, 1.0, v118
    v_add_f32 v119, 1.0, v119
    v_rcp_f32 v112, v112
    v_rcp_f32 v113, v113
    v_rcp_f32 v114, v114
    v_rcp_f32 v115, v115
    v_rcp_f32 v116, v116
    v_rcp_f32 v117, v117
    v_rcp_f32 v118, v118
    v_rcp_f32 v119, v119
    v_mul_f32 v112, v112, v64
    v_mul_f32 v113, v113, v65
    v_mul_f32 v114, v114, v66
    v_mul_f32 v115, v115, v67
    v_mul_f32 v116, v116, v68
    v_mul_f32 v117, v117, v69
    v_mul_f32 v118, v118, v70
    v_mul_f32 v119, v119, v71
    v_cvt_pk_bf16_f32 v104, v112, v113
    v_cvt_pk_bf16_f32 v105, v114, v115
    v_cvt_pk_bf16_f32 v106, v116, v117
    v_cvt_pk_bf16_f32 v107, v118, v119
    v_mul_f32 v72, v72, v5
    v_mul_f32 v73, v73, v5
    v_mul_f32 v74, v74, v5
    v_mul_f32 v75, v75, v5
    v_mul_f32 v76, v76, v5
    v_mul_f32 v77, v77, v5
    v_mul_f32 v78, v78, v5
    v_mul_f32 v79, v79, v5
    v_cvt_pk_bf16_f32 v108, v72, v73
    v_cvt_pk_bf16_f32 v109, v74, v75
    v_cvt_pk_bf16_f32 v110, v76, v77
    v_cvt_pk_bf16_f32 v111, v78, v79
    v_lshlrev_b32 v72, 16, v108
    v_and_b32 v73, 0xffff0000, v108
    v_lshlrev_b32 v74, 16, v109
    v_and_b32 v75, 0xffff0000, v109
    v_lshlrev_b32 v76, 16, v110
    v_and_b32 v77, 0xffff0000, v110
    v_lshlrev_b32 v78, 16, v111
    v_and_b32 v79, 0xffff0000, v111
    v_mul_f32 v112, v72, v72
    v_mul_f32 v113, v73, v73
    v_mul_f32 v114, v74, v74
    v_mul_f32 v115, v75, v75
    v_mul_f32 v116, v76, v76
    v_mul_f32 v117, v77, v77
    v_mul_f32 v118, v78, v78
    v_mul_f32 v119, v79, v79
    v_fma_f32 v112, v112, s56, v120
    v_fma_f32 v113, v113, s57, v121
    v_fma_f32 v114, v114, s56, v120
    v_fma_f32 v115, v115, s57, v121
    v_fma_f32 v116, v116, s56, v120
    v_fma_f32 v117, v117, s57, v121
    v_fma_f32 v118, v118, s56, v120
    v_fma_f32 v119, v119, s57, v121
    v_mul_f32 v112, v112, v72
    v_mul_f32 v113, v113, v73
    v_mul_f32 v114, v114, v74
    v_mul_f32 v115, v115, v75
    v_mul_f32 v116, v116, v76
    v_mul_f32 v117, v117, v77
    v_mul_f32 v118, v118, v78
    v_mul_f32 v119, v119, v79
    v_exp_f32 v112, v112
    v_exp_f32 v113, v113
    v_exp_f32 v114, v114
    v_exp_f32 v115, v115
    v_exp_f32 v116, v116
    v_exp_f32 v117, v117
    v_exp_f32 v118, v118
    v_exp_f32 v119, v119
    v_add_f32 v112, 1.0, v112
    v_add_f32 v113, 1.0, v113
    v_add_f32 v114, 1.0, v114
    v_add_f32 v115, 1.0, v115
    v_add_f32 v116, 1.0, v116
    v_add_f32 v117, 1.0, v117
    v_add_f32 v118, 1.0, v118
    v_add_f32 v119, 1.0, v119
    v_rcp_f32 v112, v112
    v_rcp_f32 v113, v113
    v_rcp_f32 v114, v114
    v_rcp_f32 v115, v115
    v_rcp_f32 v116, v116
    v_rcp_f32 v117, v117
    v_rcp_f32 v118, v118
    v_rcp_f32 v119, v119
    v_mul_f32 v112, v112, v72
    v_mul_f32 v113, v113, v73
    v_mul_f32 v114, v114, v74
    v_mul_f32 v115, v115, v75
    v_mul_f32 v116, v116, v76
    v_mul_f32 v117, v117, v77
    v_mul_f32 v118, v118, v78
    v_mul_f32 v119, v119, v79
    v_cvt_pk_bf16_f32 v108, v112, v113
    v_cvt_pk_bf16_f32 v109, v114, v115
    v_cvt_pk_bf16_f32 v110, v116, v117
    v_cvt_pk_bf16_f32 v111, v118, v119
    s_and_b32 s55, s44, 1
    s_lshl_b32 s54, s46, 18
    s_lshl_b32 s58, s55, 17
    s_add_u32 s54, s54, s58
    s_add_u32 s58, s54, 6291456
    s_add_u32 s59, s54, 6356992
    s_add_u32 s60, s54, 10485760
    s_add_u32 s61, s54, 10551296
    v_lshlrev_b32 v48, 16, v96
    v_and_b32 v49, 0xffff0000, v96
    v_mov_b32 v112, v48
    v_mul_f32 v113, v48, v48
    v_mov_b32 v114, v49
    v_mul_f32 v115, v49, v49
    v_lshlrev_b32 v64, 16, v104
    v_and_b32 v65, 0xffff0000, v104
    v_mov_b32 v116, v64
    v_mul_f32 v117, v64, v64
    v_mov_b32 v118, v65
    v_mul_f32 v119, v65, v65
    v_lshlrev_b32 v50, 16, v97
    v_and_b32 v51, 0xffff0000, v97
    v_add_f32 v112, v112, v50
    v_fmac_f32 v113, v50, v50
    v_add_f32 v114, v114, v51
    v_fmac_f32 v115, v51, v51
    v_lshlrev_b32 v66, 16, v105
    v_and_b32 v67, 0xffff0000, v105
    v_add_f32 v116, v116, v66
    v_fmac_f32 v117, v66, v66
    v_add_f32 v118, v118, v67
    v_fmac_f32 v119, v67, v67
    v_lshlrev_b32 v52, 16, v98
    v_and_b32 v53, 0xffff0000, v98
    v_add_f32 v112, v112, v52
    v_fmac_f32 v113, v52, v52
    v_add_f32 v114, v114, v53
    v_fmac_f32 v115, v53, v53
    v_lshlrev_b32 v68, 16, v106
    v_and_b32 v69, 0xffff0000, v106
    v_add_f32 v116, v116, v68
    v_fmac_f32 v117, v68, v68
    v_add_f32 v118, v118, v69
    v_fmac_f32 v119, v69, v69
    v_lshlrev_b32 v54, 16, v99
    v_and_b32 v55, 0xffff0000, v99
    v_add_f32 v112, v112, v54
    v_fmac_f32 v113, v54, v54
    v_add_f32 v114, v114, v55
    v_fmac_f32 v115, v55, v55
    v_lshlrev_b32 v70, 16, v107
    v_and_b32 v71, 0xffff0000, v107
    v_add_f32 v116, v116, v70
    v_fmac_f32 v117, v70, v70
    v_add_f32 v118, v118, v71
    v_fmac_f32 v119, v71, v71
    v_lshlrev_b32 v56, 16, v100
    v_and_b32 v57, 0xffff0000, v100
    v_add_f32 v112, v112, v56
    v_fmac_f32 v113, v56, v56
    v_add_f32 v114, v114, v57
    v_fmac_f32 v115, v57, v57
    v_lshlrev_b32 v72, 16, v108
    v_and_b32 v73, 0xffff0000, v108
    v_add_f32 v116, v116, v72
    v_fmac_f32 v117, v72, v72
    v_add_f32 v118, v118, v73
    v_fmac_f32 v119, v73, v73
    v_lshlrev_b32 v58, 16, v101
    v_and_b32 v59, 0xffff0000, v101
    v_add_f32 v112, v112, v58
    v_fmac_f32 v113, v58, v58
    v_add_f32 v114, v114, v59
    v_fmac_f32 v115, v59, v59
    v_lshlrev_b32 v74, 16, v109
    v_and_b32 v75, 0xffff0000, v109
    v_add_f32 v116, v116, v74
    v_fmac_f32 v117, v74, v74
    v_add_f32 v118, v118, v75
    v_fmac_f32 v119, v75, v75
    v_lshlrev_b32 v60, 16, v102
    v_and_b32 v61, 0xffff0000, v102
    v_add_f32 v112, v112, v60
    v_fmac_f32 v113, v60, v60
    v_add_f32 v114, v114, v61
    v_fmac_f32 v115, v61, v61
    v_lshlrev_b32 v76, 16, v110
    v_and_b32 v77, 0xffff0000, v110
    v_add_f32 v116, v116, v76
    v_fmac_f32 v117, v76, v76
    v_add_f32 v118, v118, v77
    v_fmac_f32 v119, v77, v77
    v_lshlrev_b32 v62, 16, v103
    v_and_b32 v63, 0xffff0000, v103
    v_add_f32 v112, v112, v62
    v_fmac_f32 v113, v62, v62
    v_add_f32 v114, v114, v63
    v_fmac_f32 v115, v63, v63
    v_lshlrev_b32 v78, 16, v111
    v_and_b32 v79, 0xffff0000, v111
    v_add_f32 v116, v116, v78
    v_fmac_f32 v117, v78, v78
    v_add_f32 v118, v118, v79
    v_fmac_f32 v119, v79, v79
    v_lshl_add_u32 v124, s55, 1, v124
    v_lshlrev_b32 v124, 10, v124
    v_lshl_add_u32 v124, v122, 3, v124
    v_add_u32 v124, 32768, v124
    v_add_f32 v112, v112, v114
    v_add_f32 v113, v113, v115
    v_add_f32 v116, v116, v118
    v_add_f32 v117, v117, v119
    ds_write_b64 v124, v[112:113]
    ds_write_b64 v124, v[116:117] offset:256
    v_lshlrev_b32 v125, 3, v122
    v_add_u32 v125, 36864, v125
    s_waitcnt lgkmcnt(0)
    s_barrier
    v_mul_f32 v16, v16, v4
    v_mul_f32 v17, v17, v4
    v_mul_f32 v18, v18, v4
    v_mul_f32 v19, v19, v4
    v_mul_f32 v20, v20, v4
    v_mul_f32 v21, v21, v4
    v_mul_f32 v22, v22, v4
    v_mul_f32 v23, v23, v4
    v_cvt_pk_bf16_f32 v80, v16, v17
    v_cvt_pk_bf16_f32 v81, v18, v19
    v_cvt_pk_bf16_f32 v82, v20, v21
    v_cvt_pk_bf16_f32 v83, v22, v23
    v_lshlrev_b32 v16, 16, v80
    v_and_b32 v17, 0xffff0000, v80
    v_lshlrev_b32 v18, 16, v81
    v_and_b32 v19, 0xffff0000, v81
    v_lshlrev_b32 v20, 16, v82
    v_and_b32 v21, 0xffff0000, v82
    v_lshlrev_b32 v22, 16, v83
    v_and_b32 v23, 0xffff0000, v83
    v_mul_f32 v112, v16, v16
    v_mul_f32 v113, v17, v17
    v_mul_f32 v114, v18, v18
    v_mul_f32 v115, v19, v19
    v_mul_f32 v116, v20, v20
    v_mul_f32 v117, v21, v21
    v_mul_f32 v118, v22, v22
    v_mul_f32 v119, v23, v23
    v_fma_f32 v112, v112, s56, v120
    v_fma_f32 v113, v113, s57, v121
    v_fma_f32 v114, v114, s56, v120
    v_fma_f32 v115, v115, s57, v121
    v_fma_f32 v116, v116, s56, v120
    v_fma_f32 v117, v117, s57, v121
    v_fma_f32 v118, v118, s56, v120
    v_fma_f32 v119, v119, s57, v121
    v_mul_f32 v112, v112, v16
    v_mul_f32 v113, v113, v17
    v_mul_f32 v114, v114, v18
    v_mul_f32 v115, v115, v19
    v_mul_f32 v116, v116, v20
    v_mul_f32 v117, v117, v21
    v_mul_f32 v118, v118, v22
    v_mul_f32 v119, v119, v23
    v_exp_f32 v112, v112
    v_exp_f32 v113, v113
    v_exp_f32 v114, v114
    v_exp_f32 v115, v115
    v_exp_f32 v116, v116
    v_exp_f32 v117, v117
    v_exp_f32 v118, v118
    v_exp_f32 v119, v119
    v_add_f32 v112, 1.0, v112
    v_add_f32 v113, 1.0, v113
    v_add_f32 v114, 1.0, v114
    v_add_f32 v115, 1.0, v115
    v_add_f32 v116, 1.0, v116
    v_add_f32 v117, 1.0, v117
    v_add_f32 v118, 1.0, v118
    v_add_f32 v119, 1.0, v119
    v_rcp_f32 v112, v112
    v_rcp_f32 v113, v113
    v_rcp_f32 v114, v114
    v_rcp_f32 v115, v115
    v_rcp_f32 v116, v116
    v_rcp_f32 v117, v117
    v_rcp_f32 v118, v118
    v_rcp_f32 v119, v119
    v_mul_f32 v112, v112, v16
    v_mul_f32 v113, v113, v17
    v_mul_f32 v114, v114, v18
    v_mul_f32 v115, v115, v19
    v_mul_f32 v116, v116, v20
    v_mul_f32 v117, v117, v21
    v_mul_f32 v118, v118, v22
    v_mul_f32 v119, v119, v23
    v_cvt_pk_bf16_f32 v80, v112, v113
    v_cvt_pk_bf16_f32 v81, v114, v115
    v_cvt_pk_bf16_f32 v82, v116, v117
    v_cvt_pk_bf16_f32 v83, v118, v119
    v_mul_f32 v24, v24, v4
    v_mul_f32 v25, v25, v4
    v_mul_f32 v26, v26, v4
    v_mul_f32 v27, v27, v4
    v_mul_f32 v28, v28, v4
    v_mul_f32 v29, v29, v4
    v_mul_f32 v30, v30, v4
    v_mul_f32 v31, v31, v4
    v_cvt_pk_bf16_f32 v84, v24, v25
    v_cvt_pk_bf16_f32 v85, v26, v27
    v_cvt_pk_bf16_f32 v86, v28, v29
    v_cvt_pk_bf16_f32 v87, v30, v31
    v_lshlrev_b32 v24, 16, v84
    v_and_b32 v25, 0xffff0000, v84
    v_lshlrev_b32 v26, 16, v85
    v_and_b32 v27, 0xffff0000, v85
    v_lshlrev_b32 v28, 16, v86
    v_and_b32 v29, 0xffff0000, v86
    v_lshlrev_b32 v30, 16, v87
    v_and_b32 v31, 0xffff0000, v87
    v_mul_f32 v112, v24, v24
    v_mul_f32 v113, v25, v25
    v_mul_f32 v114, v26, v26
    v_mul_f32 v115, v27, v27
    v_mul_f32 v116, v28, v28
    v_mul_f32 v117, v29, v29
    v_mul_f32 v118, v30, v30
    v_mul_f32 v119, v31, v31
    v_fma_f32 v112, v112, s56, v120
    v_fma_f32 v113, v113, s57, v121
    v_fma_f32 v114, v114, s56, v120
    v_fma_f32 v115, v115, s57, v121
    v_fma_f32 v116, v116, s56, v120
    v_fma_f32 v117, v117, s57, v121
    v_fma_f32 v118, v118, s56, v120
    v_fma_f32 v119, v119, s57, v121
    v_mul_f32 v112, v112, v24
    v_mul_f32 v113, v113, v25
    v_mul_f32 v114, v114, v26
    v_mul_f32 v115, v115, v27
    v_mul_f32 v116, v116, v28
    v_mul_f32 v117, v117, v29
    v_mul_f32 v118, v118, v30
    v_mul_f32 v119, v119, v31
    v_exp_f32 v112, v112
    v_exp_f32 v113, v113
    v_exp_f32 v114, v114
    v_exp_f32 v115, v115
    v_exp_f32 v116, v116
    v_exp_f32 v117, v117
    v_exp_f32 v118, v118
    v_exp_f32 v119, v119
    v_add_f32 v112, 1.0, v112
    v_add_f32 v113, 1.0, v113
    v_add_f32 v114, 1.0, v114
    v_add_f32 v115, 1.0, v115
    v_add_f32 v116, 1.0, v116
    v_add_f32 v117, 1.0, v117
    v_add_f32 v118, 1.0, v118
    v_add_f32 v119, 1.0, v119
    v_rcp_f32 v112, v112
    v_rcp_f32 v113, v113
    v_rcp_f32 v114, v114
    v_rcp_f32 v115, v115
    v_rcp_f32 v116, v116
    v_rcp_f32 v117, v117
    v_rcp_f32 v118, v118
    v_rcp_f32 v119, v119
    v_mul_f32 v112, v112, v24
    v_mul_f32 v113, v113, v25
    v_mul_f32 v114, v114, v26
    v_mul_f32 v115, v115, v27
    v_mul_f32 v116, v116, v28
    v_mul_f32 v117, v117, v29
    v_mul_f32 v118, v118, v30
    v_mul_f32 v119, v119, v31
    v_cvt_pk_bf16_f32 v84, v112, v113
    v_cvt_pk_bf16_f32 v85, v114, v115
    v_cvt_pk_bf16_f32 v86, v116, v117
    v_cvt_pk_bf16_f32 v87, v118, v119
    v_mul_f32 v32, v32, v5
    v_mul_f32 v33, v33, v5
    v_mul_f32 v34, v34, v5
    v_mul_f32 v35, v35, v5
    v_mul_f32 v36, v36, v5
    v_mul_f32 v37, v37, v5
    v_mul_f32 v38, v38, v5
    v_mul_f32 v39, v39, v5
    v_cvt_pk_bf16_f32 v88, v32, v33
    v_cvt_pk_bf16_f32 v89, v34, v35
    v_cvt_pk_bf16_f32 v90, v36, v37
    v_cvt_pk_bf16_f32 v91, v38, v39
    v_lshlrev_b32 v32, 16, v88
    v_and_b32 v33, 0xffff0000, v88
    v_lshlrev_b32 v34, 16, v89
    v_and_b32 v35, 0xffff0000, v89
    v_lshlrev_b32 v36, 16, v90
    v_and_b32 v37, 0xffff0000, v90
    v_lshlrev_b32 v38, 16, v91
    v_and_b32 v39, 0xffff0000, v91
    v_mul_f32 v112, v32, v32
    v_mul_f32 v113, v33, v33
    v_mul_f32 v114, v34, v34
    v_mul_f32 v115, v35, v35
    v_mul_f32 v116, v36, v36
    v_mul_f32 v117, v37, v37
    v_mul_f32 v118, v38, v38
    v_mul_f32 v119, v39, v39
    v_fma_f32 v112, v112, s56, v120
    v_fma_f32 v113, v113, s57, v121
    v_fma_f32 v114, v114, s56, v120
    v_fma_f32 v115, v115, s57, v121
    v_fma_f32 v116, v116, s56, v120
    v_fma_f32 v117, v117, s57, v121
    v_fma_f32 v118, v118, s56, v120
    v_fma_f32 v119, v119, s57, v121
    v_mul_f32 v112, v112, v32
    v_mul_f32 v113, v113, v33
    v_mul_f32 v114, v114, v34
    v_mul_f32 v115, v115, v35
    v_mul_f32 v116, v116, v36
    v_mul_f32 v117, v117, v37
    v_mul_f32 v118, v118, v38
    v_mul_f32 v119, v119, v39
    v_exp_f32 v112, v112
    v_exp_f32 v113, v113
    v_exp_f32 v114, v114
    v_exp_f32 v115, v115
    v_exp_f32 v116, v116
    v_exp_f32 v117, v117
    v_exp_f32 v118, v118
    v_exp_f32 v119, v119
    v_add_f32 v112, 1.0, v112
    v_add_f32 v113, 1.0, v113
    v_add_f32 v114, 1.0, v114
    v_add_f32 v115, 1.0, v115
    v_add_f32 v116, 1.0, v116
    v_add_f32 v117, 1.0, v117
    v_add_f32 v118, 1.0, v118
    v_add_f32 v119, 1.0, v119
    v_rcp_f32 v112, v112
    v_rcp_f32 v113, v113
    v_rcp_f32 v114, v114
    v_rcp_f32 v115, v115
    v_rcp_f32 v116, v116
    v_rcp_f32 v117, v117
    v_rcp_f32 v118, v118
    v_rcp_f32 v119, v119
    v_mul_f32 v112, v112, v32
    v_mul_f32 v113, v113, v33
    v_mul_f32 v114, v114, v34
    v_mul_f32 v115, v115, v35
    v_mul_f32 v116, v116, v36
    v_mul_f32 v117, v117, v37
    v_mul_f32 v118, v118, v38
    v_mul_f32 v119, v119, v39
    v_cvt_pk_bf16_f32 v88, v112, v113
    v_cvt_pk_bf16_f32 v89, v114, v115
    v_cvt_pk_bf16_f32 v90, v116, v117
    v_cvt_pk_bf16_f32 v91, v118, v119
    v_mul_f32 v40, v40, v5
    v_mul_f32 v41, v41, v5
    v_mul_f32 v42, v42, v5
    v_mul_f32 v43, v43, v5
    v_mul_f32 v44, v44, v5
    v_mul_f32 v45, v45, v5
    v_mul_f32 v46, v46, v5
    v_mul_f32 v47, v47, v5
    v_cvt_pk_bf16_f32 v92, v40, v41
    v_cvt_pk_bf16_f32 v93, v42, v43
    v_cvt_pk_bf16_f32 v94, v44, v45
    v_cvt_pk_bf16_f32 v95, v46, v47
    v_lshlrev_b32 v40, 16, v92
    v_and_b32 v41, 0xffff0000, v92
    v_lshlrev_b32 v42, 16, v93
    v_and_b32 v43, 0xffff0000, v93
    v_lshlrev_b32 v44, 16, v94
    v_and_b32 v45, 0xffff0000, v94
    v_lshlrev_b32 v46, 16, v95
    v_and_b32 v47, 0xffff0000, v95
    v_mul_f32 v112, v40, v40
    v_mul_f32 v113, v41, v41
    v_mul_f32 v114, v42, v42
    v_mul_f32 v115, v43, v43
    v_mul_f32 v116, v44, v44
    v_mul_f32 v117, v45, v45
    v_mul_f32 v118, v46, v46
    v_mul_f32 v119, v47, v47
    v_fma_f32 v112, v112, s56, v120
    v_fma_f32 v113, v113, s57, v121
    v_fma_f32 v114, v114, s56, v120
    v_fma_f32 v115, v115, s57, v121
    v_fma_f32 v116, v116, s56, v120
    v_fma_f32 v117, v117, s57, v121
    v_fma_f32 v118, v118, s56, v120
    v_fma_f32 v119, v119, s57, v121
    v_mul_f32 v112, v112, v40
    v_mul_f32 v113, v113, v41
    v_mul_f32 v114, v114, v42
    v_mul_f32 v115, v115, v43
    v_mul_f32 v116, v116, v44
    v_mul_f32 v117, v117, v45
    v_mul_f32 v118, v118, v46
    v_mul_f32 v119, v119, v47
    v_exp_f32 v112, v112
    v_exp_f32 v113, v113
    v_exp_f32 v114, v114
    v_exp_f32 v115, v115
    v_exp_f32 v116, v116
    v_exp_f32 v117, v117
    v_exp_f32 v118, v118
    v_exp_f32 v119, v119
    v_add_f32 v112, 1.0, v112
    v_add_f32 v113, 1.0, v113
    v_add_f32 v114, 1.0, v114
    v_add_f32 v115, 1.0, v115
    v_add_f32 v116, 1.0, v116
    v_add_f32 v117, 1.0, v117
    v_add_f32 v118, 1.0, v118
    v_add_f32 v119, 1.0, v119
    v_rcp_f32 v112, v112
    v_rcp_f32 v113, v113
    v_rcp_f32 v114, v114
    v_rcp_f32 v115, v115
    v_rcp_f32 v116, v116
    v_rcp_f32 v117, v117
    v_rcp_f32 v118, v118
    v_rcp_f32 v119, v119
    v_mul_f32 v112, v112, v40
    v_mul_f32 v113, v113, v41
    v_mul_f32 v114, v114, v42
    v_mul_f32 v115, v115, v43
    v_mul_f32 v116, v116, v44
    v_mul_f32 v117, v117, v45
    v_mul_f32 v118, v118, v46
    v_mul_f32 v119, v119, v47
    v_cvt_pk_bf16_f32 v92, v112, v113
    v_cvt_pk_bf16_f32 v93, v114, v115
    v_cvt_pk_bf16_f32 v94, v116, v117
    v_cvt_pk_bf16_f32 v95, v118, v119
    buffer_store_dwordx4 v[80:83], v123, s[28:31], s58 offen offset:0 sc1
    buffer_store_dwordx4 v[88:91], v123, s[28:31], s58 offen offset:1024 sc1
    buffer_store_dwordx4 v[84:87], v123, s[28:31], s59 offen offset:0 sc1
    buffer_store_dwordx4 v[92:95], v123, s[28:31], s59 offen offset:1024 sc1
    s_barrier
    ds_read_b64 v[6:7], v125
    ds_read_b64 v[8:9], v125 offset:256
    s_waitcnt lgkmcnt(0)
    v_sub_f32 v48, v48, v6
    v_sub_f32 v50, v50, v6
    v_sub_f32 v52, v52, v6
    v_sub_f32 v54, v54, v6
    v_sub_f32 v49, v49, v6
    v_sub_f32 v51, v51, v6
    v_sub_f32 v53, v53, v6
    v_sub_f32 v55, v55, v6
    v_cvt_pk_bf16_f32 v96, v48, v49
    v_cvt_pk_bf16_f32 v97, v50, v51
    v_cvt_pk_bf16_f32 v98, v52, v53
    v_cvt_pk_bf16_f32 v99, v54, v55
    v_lshlrev_b32 v48, 16, v96
    v_lshlrev_b32 v50, 16, v97
    v_lshlrev_b32 v52, 16, v98
    v_lshlrev_b32 v54, 16, v99
    v_and_b32 v49, 0xffff0000, v96
    v_and_b32 v51, 0xffff0000, v97
    v_and_b32 v53, 0xffff0000, v98
    v_and_b32 v55, 0xffff0000, v99
    v_mul_f32 v48, v48, v7
    v_mul_f32 v50, v50, v7
    v_mul_f32 v52, v52, v7
    v_mul_f32 v54, v54, v7
    v_mul_f32 v49, v49, v7
    v_mul_f32 v51, v51, v7
    v_mul_f32 v53, v53, v7
    v_mul_f32 v55, v55, v7
    v_cvt_pk_bf16_f32 v96, v48, v49
    v_cvt_pk_bf16_f32 v97, v50, v51
    v_cvt_pk_bf16_f32 v98, v52, v53
    v_cvt_pk_bf16_f32 v99, v54, v55
    buffer_store_dwordx4 v[96:99], v123, s[28:31], s60 offen offset:0 sc1
    v_sub_f32 v64, v64, v8
    v_sub_f32 v66, v66, v8
    v_sub_f32 v68, v68, v8
    v_sub_f32 v70, v70, v8
    v_sub_f32 v65, v65, v8
    v_sub_f32 v67, v67, v8
    v_sub_f32 v69, v69, v8
    v_sub_f32 v71, v71, v8
    v_cvt_pk_bf16_f32 v104, v64, v65
    v_cvt_pk_bf16_f32 v105, v66, v67
    v_cvt_pk_bf16_f32 v106, v68, v69
    v_cvt_pk_bf16_f32 v107, v70, v71
    v_lshlrev_b32 v64, 16, v104
    v_lshlrev_b32 v66, 16, v105
    v_lshlrev_b32 v68, 16, v106
    v_lshlrev_b32 v70, 16, v107
    v_and_b32 v65, 0xffff0000, v104
    v_and_b32 v67, 0xffff0000, v105
    v_and_b32 v69, 0xffff0000, v106
    v_and_b32 v71, 0xffff0000, v107
    v_mul_f32 v64, v64, v9
    v_mul_f32 v66, v66, v9
    v_mul_f32 v68, v68, v9
    v_mul_f32 v70, v70, v9
    v_mul_f32 v65, v65, v9
    v_mul_f32 v67, v67, v9
    v_mul_f32 v69, v69, v9
    v_mul_f32 v71, v71, v9
    v_cvt_pk_bf16_f32 v104, v64, v65
    v_cvt_pk_bf16_f32 v105, v66, v67
    v_cvt_pk_bf16_f32 v106, v68, v69
    v_cvt_pk_bf16_f32 v107, v70, v71
    buffer_store_dwordx4 v[104:107], v123, s[28:31], s60 offen offset:1024 sc1
    v_sub_f32 v56, v56, v6
    v_sub_f32 v58, v58, v6
    v_sub_f32 v60, v60, v6
    v_sub_f32 v62, v62, v6
    v_sub_f32 v57, v57, v6
    v_sub_f32 v59, v59, v6
    v_sub_f32 v61, v61, v6
    v_sub_f32 v63, v63, v6
    v_cvt_pk_bf16_f32 v100, v56, v57
    v_cvt_pk_bf16_f32 v101, v58, v59
    v_cvt_pk_bf16_f32 v102, v60, v61
    v_cvt_pk_bf16_f32 v103, v62, v63
    v_lshlrev_b32 v56, 16, v100
    v_lshlrev_b32 v58, 16, v101
    v_lshlrev_b32 v60, 16, v102
    v_lshlrev_b32 v62, 16, v103
    v_and_b32 v57, 0xffff0000, v100
    v_and_b32 v59, 0xffff0000, v101
    v_and_b32 v61, 0xffff0000, v102
    v_and_b32 v63, 0xffff0000, v103
    v_mul_f32 v56, v56, v7
    v_mul_f32 v58, v58, v7
    v_mul_f32 v60, v60, v7
    v_mul_f32 v62, v62, v7
    v_mul_f32 v57, v57, v7
    v_mul_f32 v59, v59, v7
    v_mul_f32 v61, v61, v7
    v_mul_f32 v63, v63, v7
    v_cvt_pk_bf16_f32 v100, v56, v57
    v_cvt_pk_bf16_f32 v101, v58, v59
    v_cvt_pk_bf16_f32 v102, v60, v61
    v_cvt_pk_bf16_f32 v103, v62, v63
    buffer_store_dwordx4 v[100:103], v123, s[28:31], s61 offen offset:0 sc1
    v_sub_f32 v72, v72, v8
    v_sub_f32 v74, v74, v8
    v_sub_f32 v76, v76, v8
    v_sub_f32 v78, v78, v8
    v_sub_f32 v73, v73, v8
    v_sub_f32 v75, v75, v8
    v_sub_f32 v77, v77, v8
    v_sub_f32 v79, v79, v8
    v_cvt_pk_bf16_f32 v108, v72, v73
    v_cvt_pk_bf16_f32 v109, v74, v75
    v_cvt_pk_bf16_f32 v110, v76, v77
    v_cvt_pk_bf16_f32 v111, v78, v79
    v_lshlrev_b32 v72, 16, v108
    v_lshlrev_b32 v74, 16, v109
    v_lshlrev_b32 v76, 16, v110
    v_lshlrev_b32 v78, 16, v111
    v_and_b32 v73, 0xffff0000, v108
    v_and_b32 v75, 0xffff0000, v109
    v_and_b32 v77, 0xffff0000, v110
    v_and_b32 v79, 0xffff0000, v111
    v_mul_f32 v72, v72, v9
    v_mul_f32 v74, v74, v9
    v_mul_f32 v76, v76, v9
    v_mul_f32 v78, v78, v9
    v_mul_f32 v73, v73, v9
    v_mul_f32 v75, v75, v9
    v_mul_f32 v77, v77, v9
    v_mul_f32 v79, v79, v9
    v_cvt_pk_bf16_f32 v108, v72, v73
    v_cvt_pk_bf16_f32 v109, v74, v75
    v_cvt_pk_bf16_f32 v110, v76, v77
    v_cvt_pk_bf16_f32 v111, v78, v79
    buffer_store_dwordx4 v[108:111], v123, s[28:31], s61 offen offset:1024 sc1
    s_lshr_b32 s54, s44, 1
    s_mul_i32 s54, s54, 4096
    v_add_u32 v4, s54, v2
    v_xor_b32 v5, 32, v4
    v_xor_b32 v6, 64, v4
    v_xor_b32 v7, 96, v4
    s_and_b32 s54, s44, 1
    s_mul_i32 s54, s54, 4608
    s_add_u32 s54, s54, 24576
    v_lshrrev_b32 v8, 7, v3
    v_lshlrev_b32 v8, 5, v8
    v_and_b32 v9, 31, v3
    v_add3_u32 v8, v8, v9, s54
    v_bfe_u32 v9, v1, 4, 1
    v_mul_u32_u24 v9, 1152, v9
    v_add_u32 v8, v8, v9
    v_mov_b32 v16, 0
    v_mov_b32 v17, 0
    v_mov_b32 v18, 0
    v_mov_b32 v19, 0
    v_mov_b32 v20, 0
    v_mov_b32 v21, 0
    v_mov_b32 v22, 0
    v_mov_b32 v23, 0
    v_mov_b32 v24, 0
    v_mov_b32 v25, 0
    v_mov_b32 v26, 0
    v_mov_b32 v27, 0
    v_mov_b32 v28, 0
    v_mov_b32 v29, 0
    v_mov_b32 v30, 0
    v_mov_b32 v31, 0
    v_mov_b32 v32, 0
    v_mov_b32 v33, 0
    v_mov_b32 v34, 0
    v_mov_b32 v35, 0
    v_mov_b32 v36, 0
    v_mov_b32 v37, 0
    v_mov_b32 v38, 0
    v_mov_b32 v39, 0
    v_mov_b32 v40, 0
    v_mov_b32 v41, 0
    v_mov_b32 v42, 0
    v_mov_b32 v43, 0
    v_mov_b32 v44, 0
    v_mov_b32 v45, 0
    v_mov_b32 v46, 0
    v_mov_b32 v47, 0
    s_mov_b32 s40, s16
    s_mov_b32 s41, s17
    s_mov_b32 s42, 4096
    s_mov_b32 s43, 0x00020000
    v_lshlrev_b32 v112, 1, v13
    s_and_b32 s55, s44, 1
    s_lshl_b32 s58, s48, 19
    s_lshl_b32 s55, s55, 18
    s_add_u32 s58, s58, s55
    s_add_u32 s59, s58, 6291456
    s_add_u32 s58, s58, 16777216
    v_lshrrev_b32 v116, 3, v1
    v_lshlrev_b32 v116, 16, v116
    v_and_b32 v117, 7, v1
    v_lshl_add_u32 v116, v117, 7, v116
    s_bfe_u32 s60, s3, 0x20003
    s_lshl_b32 s61, s44, 2
    s_add_u32 s60, s60, s61
    s_lshl_b32 s60, s60, 10
    s_lshl_b32 s61, s48, 19
    s_add_u32 s60, s60, s61
    s_add_u32 s60, s60, 10485760
    s_waitcnt vmcnt(0)
    s_barrier
    s_bfe_u32 s54, s3, 0x20003
    s_lshl_b32 s54, s54, 2
    s_add_u32 s54, s54, s44
    s_mul_i32 s55, s54, 57344
    s_lshl_b32 s54, s54, 15
    s_lshl_b32 s56, s48, 7
    s_add_u32 s54, s54, s56
    s_add_u32 s55, s55, s56
    v_min_u32 v120, 55, v1
    v_lshlrev_b32 v120, 10, v120
    v_and_b32 v121, 31, v1
    v_lshlrev_b32 v121, 10, v121
    v_lshrrev_b32 v122, 5, v1
    v_lshl_add_u32 v121, v122, 6, v121
    s_mov_b32 s32, s18
    s_mov_b32 s33, s19
    s_mov_b32 s34, 917504
    s_mov_b32 s35, 0x00020000
    s_mov_b32 s36, s8
    s_mov_b32 s37, s9
    s_mov_b32 s38, 524288
    s_mov_b32 s39, 0x00020000
    buffer_load_dword v15, v120, s[32:35], s55 offen offset:0
    buffer_load_dword v15, v121, s[36:39], s54 offen
    s_barrier
    s_setprio 0
    s_barrier
    buffer_load_ushort v113, v112, s[40:43], 0 offen
    buffer_load_dwordx4 v[96:99], v12, s[28:31], s59 offen
    s_add_u32 s59, s59, 65536
    buffer_load_dwordx4 v[100:103], v12, s[28:31], s59 offen
    s_add_u32 s59, s59, 65536
    buffer_load_dwordx4 v[104:107], v12, s[28:31], s59 offen
    s_add_u32 s59, s59, 65536
    buffer_load_dwordx4 v[108:111], v12, s[28:31], s59 offen
    s_add_u32 s59, s59, 65536
    ds_read_b128 v[48:51], v4 offset:0
    ds_read_b64_tr_b16 v[56:57], v8 offset:0
    ds_read_b64_tr_b16 v[58:59], v8 offset:128
    ds_read_b64_tr_b16 v[60:61], v8 offset:2304
    ds_read_b64_tr_b16 v[62:63], v8 offset:2432
    ds_read_b128 v[52:55], v5 offset:0
    ds_read_b64_tr_b16 v[64:65], v8 offset:512
    ds_read_b64_tr_b16 v[66:67], v8 offset:640
    ds_read_b64_tr_b16 v[68:69], v8 offset:2816
    ds_read_b64_tr_b16 v[70:71], v8 offset:2944
    s_mov_b32 s52, 0
B2_C_LOOP:
    s_waitcnt lgkmcnt(7)
    v_mfma_f32_32x32x16_bf16 v[16:31], v[56:59], v[48:51], v[16:31]
    ds_read_b128 v[72:75], v6 offset:0
    ds_read_b64_tr_b16 v[80:81], v8 offset:9216
    ds_read_b64_tr_b16 v[82:83], v8 offset:9344
    ds_read_b64_tr_b16 v[84:85], v8 offset:11520
    s_waitcnt lgkmcnt(9)
    v_mfma_f32_32x32x16_bf16 v[32:47], v[60:63], v[48:51], v[32:47]
    ds_read_b64_tr_b16 v[86:87], v8 offset:11648
    ds_read_b128 v[76:79], v7 offset:0
    s_waitcnt lgkmcnt(8)
    v_mfma_f32_32x32x16_bf16 v[16:31], v[64:67], v[52:55], v[16:31]
    ds_read_b64_tr_b16 v[88:89], v8 offset:9728
    ds_read_b64_tr_b16 v[90:91], v8 offset:9856
    s_waitcnt lgkmcnt(8)
    v_mfma_f32_32x32x16_bf16 v[32:47], v[68:71], v[52:55], v[32:47]
    ds_read_b64_tr_b16 v[92:93], v8 offset:12032
    ds_read_b64_tr_b16 v[94:95], v8 offset:12160
    s_waitcnt lgkmcnt(7)
    v_mfma_f32_32x32x16_bf16 v[16:31], v[80:83], v[72:75], v[16:31]
    s_waitcnt lgkmcnt(5)
    v_mfma_f32_32x32x16_bf16 v[32:47], v[84:87], v[72:75], v[32:47]
    s_waitcnt lgkmcnt(0)
    s_barrier
    ds_read_b128 v[48:51], v4 offset:8192
    ds_read_b64_tr_b16 v[56:57], v8 offset:18432
    ds_read_b64_tr_b16 v[58:59], v8 offset:18560
    v_mfma_f32_32x32x16_bf16 v[16:31], v[88:91], v[76:79], v[16:31]
    ds_read_b64_tr_b16 v[60:61], v8 offset:20736
    ds_read_b64_tr_b16 v[62:63], v8 offset:20864
    ds_read_b128 v[52:55], v5 offset:8192
    ds_read_b64_tr_b16 v[64:65], v8 offset:18944
    v_mfma_f32_32x32x16_bf16 v[32:47], v[92:95], v[76:79], v[32:47]
    ds_read_b64_tr_b16 v[66:67], v8 offset:19072
    ds_read_b64_tr_b16 v[68:69], v8 offset:21248
    ds_read_b64_tr_b16 v[70:71], v8 offset:21376
    s_waitcnt lgkmcnt(7)
    v_mfma_f32_32x32x16_bf16 v[16:31], v[56:59], v[48:51], v[16:31]
    ds_read_b128 v[72:75], v6 offset:8192
    ds_read_b64_tr_b16 v[80:81], v8 offset:27648
    ds_read_b64_tr_b16 v[82:83], v8 offset:27776
    ds_read_b64_tr_b16 v[84:85], v8 offset:29952
    s_waitcnt lgkmcnt(9)
    v_mfma_f32_32x32x16_bf16 v[32:47], v[60:63], v[48:51], v[32:47]
    ds_read_b64_tr_b16 v[86:87], v8 offset:30080
    ds_read_b128 v[76:79], v7 offset:8192
    s_waitcnt lgkmcnt(8)
    v_mfma_f32_32x32x16_bf16 v[16:31], v[64:67], v[52:55], v[16:31]
    ds_read_b64_tr_b16 v[88:89], v8 offset:28160
    ds_read_b64_tr_b16 v[90:91], v8 offset:28288
    s_waitcnt lgkmcnt(8)
    v_mfma_f32_32x32x16_bf16 v[32:47], v[68:71], v[52:55], v[32:47]
    ds_read_b64_tr_b16 v[92:93], v8 offset:30464
    ds_read_b64_tr_b16 v[94:95], v8 offset:30592
    s_waitcnt lgkmcnt(7)
    v_mfma_f32_32x32x16_bf16 v[16:31], v[80:83], v[72:75], v[16:31]
    s_waitcnt lgkmcnt(5)
    v_mfma_f32_32x32x16_bf16 v[32:47], v[84:87], v[72:75], v[32:47]
    s_waitcnt lgkmcnt(0)
    s_barrier
    ds_read_b128 v[48:51], v4 offset:16384
    ds_read_b64_tr_b16 v[56:57], v8 offset:36864
    ds_read_b64_tr_b16 v[58:59], v8 offset:36992
    v_mfma_f32_32x32x16_bf16 v[16:31], v[88:91], v[76:79], v[16:31]
    ds_read_b64_tr_b16 v[60:61], v8 offset:39168
    ds_read_b64_tr_b16 v[62:63], v8 offset:39296
    ds_read_b128 v[52:55], v5 offset:16384
    ds_read_b64_tr_b16 v[64:65], v8 offset:37376
    v_mfma_f32_32x32x16_bf16 v[32:47], v[92:95], v[76:79], v[32:47]
    ds_read_b64_tr_b16 v[66:67], v8 offset:37504
    ds_read_b64_tr_b16 v[68:69], v8 offset:39680
    ds_read_b64_tr_b16 v[70:71], v8 offset:39808
    s_add_u32 s52, s52, 1
    s_cmp_lt_u32 s52, 11
    s_cbranch_scc0 B2_C_DONE
    s_waitcnt lgkmcnt(7)
    v_mfma_f32_32x32x16_bf16 v[16:31], v[56:59], v[48:51], v[16:31]
    ds_read_b128 v[72:75], v6 offset:16384
    ds_read_b64_tr_b16 v[80:81], v8 offset:46080
    ds_read_b64_tr_b16 v[82:83], v8 offset:46208
    ds_read_b64_tr_b16 v[84:85], v8 offset:48384
    s_waitcnt lgkmcnt(9)
    v_mfma_f32_32x32x16_bf16 v[32:47], v[60:63], v[48:51], v[32:47]
    ds_read_b64_tr_b16 v[86:87], v8 offset:48512
    ds_read_b128 v[76:79], v7 offset:16384
    s_waitcnt lgkmcnt(8)
    v_mfma_f32_32x32x16_bf16 v[16:31], v[64:67], v[52:55], v[16:31]
    ds_read_b64_tr_b16 v[88:89], v8 offset:46592
    ds_read_b64_tr_b16 v[90:91], v8 offset:46720
    s_waitcnt lgkmcnt(8)
    v_mfma_f32_32x32x16_bf16 v[32:47], v[68:71], v[52:55], v[32:47]
    ds_read_b64_tr_b16 v[92:93], v8 offset:48896
    ds_read_b64_tr_b16 v[94:95], v8 offset:49024
    s_waitcnt lgkmcnt(7)
    v_mfma_f32_32x32x16_bf16 v[16:31], v[80:83], v[72:75], v[16:31]
    s_waitcnt lgkmcnt(5)
    v_mfma_f32_32x32x16_bf16 v[32:47], v[84:87], v[72:75], v[32:47]
    s_waitcnt lgkmcnt(0)
    s_barrier
    ds_read_b128 v[48:51], v4 offset:0
    ds_read_b64_tr_b16 v[56:57], v8 offset:0
    ds_read_b64_tr_b16 v[58:59], v8 offset:128
    v_mfma_f32_32x32x16_bf16 v[16:31], v[88:91], v[76:79], v[16:31]
    ds_read_b64_tr_b16 v[60:61], v8 offset:2304
    ds_read_b64_tr_b16 v[62:63], v8 offset:2432
    ds_read_b128 v[52:55], v5 offset:0
    ds_read_b64_tr_b16 v[64:65], v8 offset:512
    v_mfma_f32_32x32x16_bf16 v[32:47], v[92:95], v[76:79], v[32:47]
    ds_read_b64_tr_b16 v[66:67], v8 offset:640
    ds_read_b64_tr_b16 v[68:69], v8 offset:2816
    ds_read_b64_tr_b16 v[70:71], v8 offset:2944
    s_branch B2_C_LOOP
B2_C_DONE:
    s_setprio 2
    s_waitcnt vmcnt(0)
    v_lshlrev_b32 v114, 16, v113
    v_mov_b32 v115, v114
    v_cvt_pk_bf16_f32 v116, v16, v17
    v_cvt_pk_bf16_f32 v117, v18, v19
    v_cvt_pk_bf16_f32 v118, v20, v21
    v_cvt_pk_bf16_f32 v119, v22, v23
    v_lshlrev_b32 v16, 16, v116
    v_lshlrev_b32 v18, 16, v117
    v_lshlrev_b32 v20, 16, v118
    v_lshlrev_b32 v22, 16, v119
    v_and_b32 v17, 0xffff0000, v116
    v_and_b32 v19, 0xffff0000, v117
    v_and_b32 v21, 0xffff0000, v118
    v_and_b32 v23, 0xffff0000, v119
    v_add_f32 v16, v16, v114
    v_add_f32 v17, v17, v115
    v_add_f32 v18, v18, v114
    v_add_f32 v19, v19, v115
    v_add_f32 v20, v20, v114
    v_add_f32 v21, v21, v115
    v_add_f32 v22, v22, v114
    v_add_f32 v23, v23, v115
    v_cvt_pk_bf16_f32 v116, v16, v17
    v_cvt_pk_bf16_f32 v117, v18, v19
    v_cvt_pk_bf16_f32 v118, v20, v21
    v_cvt_pk_bf16_f32 v119, v22, v23
    v_lshlrev_b32 v16, 16, v116
    v_lshlrev_b32 v18, 16, v117
    v_lshlrev_b32 v20, 16, v118
    v_lshlrev_b32 v22, 16, v119
    v_and_b32 v17, 0xffff0000, v116
    v_and_b32 v19, 0xffff0000, v117
    v_and_b32 v21, 0xffff0000, v118
    v_and_b32 v23, 0xffff0000, v119
    v_lshlrev_b32 v120, 16, v96
    v_lshlrev_b32 v122, 16, v97
    v_lshlrev_b32 v124, 16, v98
    v_lshlrev_b32 v126, 16, v99
    v_and_b32 v121, 0xffff0000, v96
    v_and_b32 v123, 0xffff0000, v97
    v_and_b32 v125, 0xffff0000, v98
    v_and_b32 v127, 0xffff0000, v99
    v_mul_f32 v16, v16, v120
    v_mul_f32 v17, v17, v121
    v_mul_f32 v18, v18, v122
    v_mul_f32 v19, v19, v123
    v_mul_f32 v20, v20, v124
    v_mul_f32 v21, v21, v125
    v_mul_f32 v22, v22, v126
    v_mul_f32 v23, v23, v127
    v_cvt_pk_bf16_f32 v96, v16, v17
    v_cvt_pk_bf16_f32 v97, v18, v19
    v_cvt_pk_bf16_f32 v98, v20, v21
    v_cvt_pk_bf16_f32 v99, v22, v23
    buffer_store_dwordx4 v[96:99], v12, s[28:31], s58 offen sc1
    s_add_u32 s58, s58, 65536
    v_cvt_pk_bf16_f32 v116, v24, v25
    v_cvt_pk_bf16_f32 v117, v26, v27
    v_cvt_pk_bf16_f32 v118, v28, v29
    v_cvt_pk_bf16_f32 v119, v30, v31
    v_lshlrev_b32 v24, 16, v116
    v_lshlrev_b32 v26, 16, v117
    v_lshlrev_b32 v28, 16, v118
    v_lshlrev_b32 v30, 16, v119
    v_and_b32 v25, 0xffff0000, v116
    v_and_b32 v27, 0xffff0000, v117
    v_and_b32 v29, 0xffff0000, v118
    v_and_b32 v31, 0xffff0000, v119
    v_add_f32 v24, v24, v114
    v_add_f32 v25, v25, v115
    v_add_f32 v26, v26, v114
    v_add_f32 v27, v27, v115
    v_add_f32 v28, v28, v114
    v_add_f32 v29, v29, v115
    v_add_f32 v30, v30, v114
    v_add_f32 v31, v31, v115
    v_cvt_pk_bf16_f32 v116, v24, v25
    v_cvt_pk_bf16_f32 v117, v26, v27
    v_cvt_pk_bf16_f32 v118, v28, v29
    v_cvt_pk_bf16_f32 v119, v30, v31
    v_lshlrev_b32 v24, 16, v116
    v_lshlrev_b32 v26, 16, v117
    v_lshlrev_b32 v28, 16, v118
    v_lshlrev_b32 v30, 16, v119
    v_and_b32 v25, 0xffff0000, v116
    v_and_b32 v27, 0xffff0000, v117
    v_and_b32 v29, 0xffff0000, v118
    v_and_b32 v31, 0xffff0000, v119
    v_lshlrev_b32 v120, 16, v100
    v_lshlrev_b32 v122, 16, v101
    v_lshlrev_b32 v124, 16, v102
    v_lshlrev_b32 v126, 16, v103
    v_and_b32 v121, 0xffff0000, v100
    v_and_b32 v123, 0xffff0000, v101
    v_and_b32 v125, 0xffff0000, v102
    v_and_b32 v127, 0xffff0000, v103
    v_mul_f32 v24, v24, v120
    v_mul_f32 v25, v25, v121
    v_mul_f32 v26, v26, v122
    v_mul_f32 v27, v27, v123
    v_mul_f32 v28, v28, v124
    v_mul_f32 v29, v29, v125
    v_mul_f32 v30, v30, v126
    v_mul_f32 v31, v31, v127
    v_cvt_pk_bf16_f32 v100, v24, v25
    v_cvt_pk_bf16_f32 v101, v26, v27
    v_cvt_pk_bf16_f32 v102, v28, v29
    v_cvt_pk_bf16_f32 v103, v30, v31
    buffer_store_dwordx4 v[100:103], v12, s[28:31], s58 offen sc1
    s_add_u32 s58, s58, 65536
    v_cvt_pk_bf16_f32 v116, v32, v33
    v_cvt_pk_bf16_f32 v117, v34, v35
    v_cvt_pk_bf16_f32 v118, v36, v37
    v_cvt_pk_bf16_f32 v119, v38, v39
    v_lshlrev_b32 v32, 16, v116
    v_lshlrev_b32 v34, 16, v117
    v_lshlrev_b32 v36, 16, v118
    v_lshlrev_b32 v38, 16, v119
    v_and_b32 v33, 0xffff0000, v116
    v_and_b32 v35, 0xffff0000, v117
    v_and_b32 v37, 0xffff0000, v118
    v_and_b32 v39, 0xffff0000, v119
    v_add_f32 v32, v32, v114
    v_add_f32 v33, v33, v115
    v_add_f32 v34, v34, v114
    v_add_f32 v35, v35, v115
    v_add_f32 v36, v36, v114
    v_add_f32 v37, v37, v115
    v_add_f32 v38, v38, v114
    v_add_f32 v39, v39, v115
    v_cvt_pk_bf16_f32 v116, v32, v33
    v_cvt_pk_bf16_f32 v117, v34, v35
    v_cvt_pk_bf16_f32 v118, v36, v37
    v_cvt_pk_bf16_f32 v119, v38, v39
    v_lshlrev_b32 v32, 16, v116
    v_lshlrev_b32 v34, 16, v117
    v_lshlrev_b32 v36, 16, v118
    v_lshlrev_b32 v38, 16, v119
    v_and_b32 v33, 0xffff0000, v116
    v_and_b32 v35, 0xffff0000, v117
    v_and_b32 v37, 0xffff0000, v118
    v_and_b32 v39, 0xffff0000, v119
    v_lshlrev_b32 v120, 16, v104
    v_lshlrev_b32 v122, 16, v105
    v_lshlrev_b32 v124, 16, v106
    v_lshlrev_b32 v126, 16, v107
    v_and_b32 v121, 0xffff0000, v104
    v_and_b32 v123, 0xffff0000, v105
    v_and_b32 v125, 0xffff0000, v106
    v_and_b32 v127, 0xffff0000, v107
    v_mul_f32 v32, v32, v120
    v_mul_f32 v33, v33, v121
    v_mul_f32 v34, v34, v122
    v_mul_f32 v35, v35, v123
    v_mul_f32 v36, v36, v124
    v_mul_f32 v37, v37, v125
    v_mul_f32 v38, v38, v126
    v_mul_f32 v39, v39, v127
    v_cvt_pk_bf16_f32 v104, v32, v33
    v_cvt_pk_bf16_f32 v105, v34, v35
    v_cvt_pk_bf16_f32 v106, v36, v37
    v_cvt_pk_bf16_f32 v107, v38, v39
    buffer_store_dwordx4 v[104:107], v12, s[28:31], s58 offen sc1
    s_add_u32 s58, s58, 65536
    v_cvt_pk_bf16_f32 v116, v40, v41
    v_cvt_pk_bf16_f32 v117, v42, v43
    v_cvt_pk_bf16_f32 v118, v44, v45
    v_cvt_pk_bf16_f32 v119, v46, v47
    v_lshlrev_b32 v40, 16, v116
    v_lshlrev_b32 v42, 16, v117
    v_lshlrev_b32 v44, 16, v118
    v_lshlrev_b32 v46, 16, v119
    v_and_b32 v41, 0xffff0000, v116
    v_and_b32 v43, 0xffff0000, v117
    v_and_b32 v45, 0xffff0000, v118
    v_and_b32 v47, 0xffff0000, v119
    v_add_f32 v40, v40, v114
    v_add_f32 v41, v41, v115
    v_add_f32 v42, v42, v114
    v_add_f32 v43, v43, v115
    v_add_f32 v44, v44, v114
    v_add_f32 v45, v45, v115
    v_add_f32 v46, v46, v114
    v_add_f32 v47, v47, v115
    v_cvt_pk_bf16_f32 v116, v40, v41
    v_cvt_pk_bf16_f32 v117, v42, v43
    v_cvt_pk_bf16_f32 v118, v44, v45
    v_cvt_pk_bf16_f32 v119, v46, v47
    v_lshlrev_b32 v40, 16, v116
    v_lshlrev_b32 v42, 16, v117
    v_lshlrev_b32 v44, 16, v118
    v_lshlrev_b32 v46, 16, v119
    v_and_b32 v41, 0xffff0000, v116
    v_and_b32 v43, 0xffff0000, v117
    v_and_b32 v45, 0xffff0000, v118
    v_and_b32 v47, 0xffff0000, v119
    v_lshlrev_b32 v120, 16, v108
    v_lshlrev_b32 v122, 16, v109
    v_lshlrev_b32 v124, 16, v110
    v_lshlrev_b32 v126, 16, v111
    v_and_b32 v121, 0xffff0000, v108
    v_and_b32 v123, 0xffff0000, v109
    v_and_b32 v125, 0xffff0000, v110
    v_and_b32 v127, 0xffff0000, v111
    v_mul_f32 v40, v40, v120
    v_mul_f32 v41, v41, v121
    v_mul_f32 v42, v42, v122
    v_mul_f32 v43, v43, v123
    v_mul_f32 v44, v44, v124
    v_mul_f32 v45, v45, v125
    v_mul_f32 v46, v46, v126
    v_mul_f32 v47, v47, v127
    v_cvt_pk_bf16_f32 v108, v40, v41
    v_cvt_pk_bf16_f32 v109, v42, v43
    v_cvt_pk_bf16_f32 v110, v44, v45
    v_cvt_pk_bf16_f32 v111, v46, v47
    buffer_store_dwordx4 v[108:111], v12, s[28:31], s58 offen sc1
    s_add_u32 s58, s58, 65536
    s_waitcnt vmcnt(0) lgkmcnt(0)
    s_barrier
BC_H:
    s_lshr_b32 s54, s44, 1
    s_mul_i32 s54, s54, 1024
    v_lshrrev_b32 v5, 5, v1
    v_bfe_u32 v6, v1, 3, 1
    v_xor_b32 v5, v5, v6
    v_and_b32 v4, 31, v1
    v_lshlrev_b32 v4, 5, v4
    v_lshl_add_u32 v4, v5, 4, v4
    v_add_u32 v4, s54, v4
    s_and_b32 s54, s44, 1
    s_mul_i32 s54, s54, 1
    s_and_b32 s55, s54, 1
    s_lshl_b32 s55, s55, 6
    s_lshr_b32 s54, s54, 1
    s_lshl_b32 s54, s54, 12
    s_add_u32 s54, s54, 32768
    v_xor_b32 v8, s55, v3
    v_add_u32 v8, s54, v8
    v_mov_b32 v16, 0
    v_mov_b32 v17, 0
    v_mov_b32 v18, 0
    v_mov_b32 v19, 0
    v_mov_b32 v20, 0
    v_mov_b32 v21, 0
    v_mov_b32 v22, 0
    v_mov_b32 v23, 0
    v_mov_b32 v24, 0
    v_mov_b32 v25, 0
    v_mov_b32 v26, 0
    v_mov_b32 v27, 0
    v_mov_b32 v28, 0
    v_mov_b32 v29, 0
    v_mov_b32 v30, 0
    v_mov_b32 v31, 0
    s_mov_b32 s40, s4
    s_mov_b32 s41, s5
    s_mov_b32 s42, 2097152
    s_mov_b32 s43, 0x00020000
    s_and_b32 s55, s44, 1
    s_lshl_b32 s55, s55, 6
    s_lshl_b32 s58, s48, 7
    s_add_u32 s58, s58, s55
    buffer_load_dwordx4 v[96:99], v14, s[40:43], s58 offen
    buffer_load_dwordx4 v[100:103], v14, s[40:43], s58 offen offset:32
    v_lshrrev_b32 v112, 4, v1
    v_lshlrev_b32 v112, 16, v112
    v_and_b32 v113, 15, v1
    v_lshl_add_u32 v112, v113, 7, v112
    s_lshl_b32 s54, s48, 2
    s_add_u32 s54, s54, s44
    s_mul_i32 s55, s54, 205
    s_lshr_b32 s55, s55, 11
    s_mul_i32 s55, s55, 10
    s_sub_u32 s54, s54, s55
    s_lshl_b32 s54, s54, 18
    s_lshl_b32 s55, s47, 11
    s_add_u32 s54, s54, s55
    s_add_u32 s54, s54, 17825792
    s_barrier
    s_barrier
    ds_read_b128 v[48:51], v4 offset:0
    ds_read_b64_tr_b16 v[56:57], v8 offset:0
    ds_read_b64_tr_b16 v[58:59], v8 offset:512
    ds_read_b128 v[52:55], v4 offset:2048
    ds_read_b64_tr_b16 v[60:61], v8 offset:2048
    ds_read_b64_tr_b16 v[62:63], v8 offset:2560
    s_mov_b32 s52, 0
B3_C_LOOP:
    s_waitcnt lgkmcnt(3)
    v_mfma_f32_32x32x16_bf16 v[16:31], v[56:59], v[48:51], v[16:31]
    ds_read_b128 v[64:67], v4 offset:4096
    ds_read_b64_tr_b16 v[72:73], v8 offset:4096
    ds_read_b64_tr_b16 v[74:75], v8 offset:4608
    s_waitcnt lgkmcnt(3)
    v_mfma_f32_32x32x16_bf16 v[16:31], v[60:63], v[52:55], v[16:31]
    ds_read_b128 v[68:71], v4 offset:6144
    ds_read_b64_tr_b16 v[76:77], v8 offset:6144
    ds_read_b64_tr_b16 v[78:79], v8 offset:6656
    s_waitcnt lgkmcnt(3)
    v_mfma_f32_32x32x16_bf16 v[16:31], v[72:75], v[64:67], v[16:31]
    s_waitcnt lgkmcnt(0)
    s_barrier
    ds_read_b128 v[48:51], v4 offset:8192
    ds_read_b64_tr_b16 v[56:57], v8 offset:8192
    ds_read_b64_tr_b16 v[58:59], v8 offset:8704
    v_mfma_f32_32x32x16_bf16 v[16:31], v[76:79], v[68:71], v[16:31]
    ds_read_b128 v[52:55], v4 offset:10240
    ds_read_b64_tr_b16 v[60:61], v8 offset:10240
    ds_read_b64_tr_b16 v[62:63], v8 offset:10752
    s_waitcnt lgkmcnt(3)
    v_mfma_f32_32x32x16_bf16 v[16:31], v[56:59], v[48:51], v[16:31]
    ds_read_b128 v[64:67], v4 offset:12288
    ds_read_b64_tr_b16 v[72:73], v8 offset:12288
    ds_read_b64_tr_b16 v[74:75], v8 offset:12800
    s_waitcnt lgkmcnt(3)
    v_mfma_f32_32x32x16_bf16 v[16:31], v[60:63], v[52:55], v[16:31]
    ds_read_b128 v[68:71], v4 offset:14336
    ds_read_b64_tr_b16 v[76:77], v8 offset:14336
    ds_read_b64_tr_b16 v[78:79], v8 offset:14848
    s_waitcnt lgkmcnt(3)
    v_mfma_f32_32x32x16_bf16 v[16:31], v[72:75], v[64:67], v[16:31]
    s_waitcnt lgkmcnt(0)
    s_barrier
    ds_read_b128 v[48:51], v4 offset:16384
    ds_read_b64_tr_b16 v[56:57], v8 offset:16384
    ds_read_b64_tr_b16 v[58:59], v8 offset:16896
    v_mfma_f32_32x32x16_bf16 v[16:31], v[76:79], v[68:71], v[16:31]
    ds_read_b128 v[52:55], v4 offset:18432
    ds_read_b64_tr_b16 v[60:61], v8 offset:18432
    ds_read_b64_tr_b16 v[62:63], v8 offset:18944
    s_add_u32 s52, s52, 1
    s_cmp_lt_u32 s52, 4
    s_cbranch_scc0 B3_C_DONE
    s_waitcnt lgkmcnt(3)
    v_mfma_f32_32x32x16_bf16 v[16:31], v[56:59], v[48:51], v[16:31]
    ds_read_b128 v[64:67], v4 offset:20480
    ds_read_b64_tr_b16 v[72:73], v8 offset:20480
    ds_read_b64_tr_b16 v[74:75], v8 offset:20992
    s_waitcnt lgkmcnt(3)
    v_mfma_f32_32x32x16_bf16 v[16:31], v[60:63], v[52:55], v[16:31]
    ds_read_b128 v[68:71], v4 offset:22528
    ds_read_b64_tr_b16 v[76:77], v8 offset:22528
    ds_read_b64_tr_b16 v[78:79], v8 offset:23040
    s_waitcnt lgkmcnt(3)
    v_mfma_f32_32x32x16_bf16 v[16:31], v[72:75], v[64:67], v[16:31]
    s_waitcnt lgkmcnt(0)
    s_barrier
    ds_read_b128 v[48:51], v4 offset:24576
    ds_read_b64_tr_b16 v[56:57], v8 offset:24576
    ds_read_b64_tr_b16 v[58:59], v8 offset:25088
    v_mfma_f32_32x32x16_bf16 v[16:31], v[76:79], v[68:71], v[16:31]
    ds_read_b128 v[52:55], v4 offset:26624
    ds_read_b64_tr_b16 v[60:61], v8 offset:26624
    ds_read_b64_tr_b16 v[62:63], v8 offset:27136
    s_waitcnt lgkmcnt(3)
    v_mfma_f32_32x32x16_bf16 v[16:31], v[56:59], v[48:51], v[16:31]
    ds_read_b128 v[64:67], v4 offset:28672
    ds_read_b64_tr_b16 v[72:73], v8 offset:28672
    ds_read_b64_tr_b16 v[74:75], v8 offset:29184
    s_waitcnt lgkmcnt(3)
    v_mfma_f32_32x32x16_bf16 v[16:31], v[60:63], v[52:55], v[16:31]
    ds_read_b128 v[68:71], v4 offset:30720
    ds_read_b64_tr_b16 v[76:77], v8 offset:30720
    ds_read_b64_tr_b16 v[78:79], v8 offset:31232
    s_waitcnt lgkmcnt(3)
    v_mfma_f32_32x32x16_bf16 v[16:31], v[72:75], v[64:67], v[16:31]
    s_waitcnt lgkmcnt(0)
    s_barrier
    ds_read_b128 v[48:51], v4 offset:0
    ds_read_b64_tr_b16 v[56:57], v8 offset:0
    ds_read_b64_tr_b16 v[58:59], v8 offset:512
    v_mfma_f32_32x32x16_bf16 v[16:31], v[76:79], v[68:71], v[16:31]
    ds_read_b128 v[52:55], v4 offset:2048
    ds_read_b64_tr_b16 v[60:61], v8 offset:2048
    ds_read_b64_tr_b16 v[62:63], v8 offset:2560
    s_branch B3_C_LOOP
B3_C_DONE:
    s_nop 5
    v_cvt_pk_bf16_f32 v104, v16, v17
    v_cvt_pk_bf16_f32 v105, v18, v19
    v_cvt_pk_bf16_f32 v106, v20, v21
    v_cvt_pk_bf16_f32 v107, v22, v23
    v_cvt_pk_bf16_f32 v108, v24, v25
    v_cvt_pk_bf16_f32 v109, v26, v27
    v_cvt_pk_bf16_f32 v110, v28, v29
    v_cvt_pk_bf16_f32 v111, v30, v31
    s_mov_b32 s40, s20
    s_mov_b32 s41, s21
    s_mov_b32 s42, 2097152
    s_mov_b32 s43, 0x00020000
    s_waitcnt lgkmcnt(0)
    s_lshr_b32 s54, s44, 1
    s_mul_i32 s54, s54, 1024
    v_lshrrev_b32 v5, 5, v1
    v_bfe_u32 v6, v1, 3, 1
    v_xor_b32 v5, v5, v6
    v_and_b32 v4, 31, v1
    v_lshlrev_b32 v4, 5, v4
    v_lshl_add_u32 v4, v5, 4, v4
    v_add_u32 v4, s54, v4
    s_and_b32 s54, s44, 1
    s_mul_i32 s54, s54, 1
    s_and_b32 s55, s54, 1
    s_lshl_b32 s55, s55, 6
    s_lshr_b32 s54, s54, 1
    s_lshl_b32 s54, s54, 12
    s_add_u32 s54, s54, 49152
    v_xor_b32 v8, s55, v3
    v_add_u32 v8, s54, v8
    v_mov_b32 v16, 0
    v_mov_b32 v17, 0
    v_mov_b32 v18, 0
    v_mov_b32 v19, 0
    v_mov_b32 v20, 0
    v_mov_b32 v21, 0
    v_mov_b32 v22, 0
    v_mov_b32 v23, 0
    v_mov_b32 v24, 0
    v_mov_b32 v25, 0
    v_mov_b32 v26, 0
    v_mov_b32 v27, 0
    v_mov_b32 v28, 0
    v_mov_b32 v29, 0
    v_mov_b32 v30, 0
    v_mov_b32 v31, 0
    s_barrier
    s_barrier
    ds_read_b128 v[48:51], v4 offset:0
    ds_read_b64_tr_b16 v[56:57], v8 offset:0
    ds_read_b64_tr_b16 v[58:59], v8 offset:512
    ds_read_b128 v[52:55], v4 offset:2048
    ds_read_b64_tr_b16 v[60:61], v8 offset:2048
    ds_read_b64_tr_b16 v[62:63], v8 offset:2560
    s_waitcnt lgkmcnt(3)
    v_mfma_f32_32x32x16_bf16 v[16:31], v[56:59], v[48:51], v[16:31]
    ds_read_b128 v[64:67], v4 offset:4096
    ds_read_b64_tr_b16 v[72:73], v8 offset:4096
    ds_read_b64_tr_b16 v[74:75], v8 offset:4608
    s_waitcnt lgkmcnt(3)
    v_mfma_f32_32x32x16_bf16 v[16:31], v[60:63], v[52:55], v[16:31]
    ds_read_b128 v[68:71], v4 offset:6144
    ds_read_b64_tr_b16 v[76:77], v8 offset:6144
    ds_read_b64_tr_b16 v[78:79], v8 offset:6656
    s_waitcnt lgkmcnt(3)
    v_mfma_f32_32x32x16_bf16 v[16:31], v[72:75], v[64:67], v[16:31]
    s_waitcnt lgkmcnt(0)
    s_barrier
    ds_read_b128 v[48:51], v4 offset:8192
    ds_read_b64_tr_b16 v[56:57], v8 offset:8192
    ds_read_b64_tr_b16 v[58:59], v8 offset:8704
    v_mfma_f32_32x32x16_bf16 v[16:31], v[76:79], v[68:71], v[16:31]
    ds_read_b128 v[52:55], v4 offset:10240
    ds_read_b64_tr_b16 v[60:61], v8 offset:10240
    ds_read_b64_tr_b16 v[62:63], v8 offset:10752
    s_waitcnt lgkmcnt(3)
    v_mfma_f32_32x32x16_bf16 v[16:31], v[56:59], v[48:51], v[16:31]
    ds_read_b128 v[64:67], v4 offset:12288
    ds_read_b64_tr_b16 v[72:73], v8 offset:12288
    ds_read_b64_tr_b16 v[74:75], v8 offset:12800
    s_waitcnt lgkmcnt(3)
    v_mfma_f32_32x32x16_bf16 v[16:31], v[60:63], v[52:55], v[16:31]
    ds_read_b128 v[68:71], v4 offset:14336
    ds_read_b64_tr_b16 v[76:77], v8 offset:14336
    ds_read_b64_tr_b16 v[78:79], v8 offset:14848
    s_waitcnt lgkmcnt(3)
    v_mfma_f32_32x32x16_bf16 v[16:31], v[72:75], v[64:67], v[16:31]
    s_waitcnt lgkmcnt(0)
    s_barrier
    ds_read_b128 v[48:51], v4 offset:16384
    ds_read_b64_tr_b16 v[56:57], v8 offset:16384
    ds_read_b64_tr_b16 v[58:59], v8 offset:16896
    v_mfma_f32_32x32x16_bf16 v[16:31], v[76:79], v[68:71], v[16:31]
    ds_read_b128 v[52:55], v4 offset:18432
    ds_read_b64_tr_b16 v[60:61], v8 offset:18432
    ds_read_b64_tr_b16 v[62:63], v8 offset:18944
    s_waitcnt lgkmcnt(3)
    v_mfma_f32_32x32x16_bf16 v[16:31], v[56:59], v[48:51], v[16:31]
    ds_read_b128 v[64:67], v4 offset:20480
    ds_read_b64_tr_b16 v[72:73], v8 offset:20480
    ds_read_b64_tr_b16 v[74:75], v8 offset:20992
    s_waitcnt lgkmcnt(3)
    v_mfma_f32_32x32x16_bf16 v[16:31], v[60:63], v[52:55], v[16:31]
    ds_read_b128 v[68:71], v4 offset:22528
    ds_read_b64_tr_b16 v[76:77], v8 offset:22528
    ds_read_b64_tr_b16 v[78:79], v8 offset:23040
    s_waitcnt lgkmcnt(3)
    v_mfma_f32_32x32x16_bf16 v[16:31], v[72:75], v[64:67], v[16:31]
    s_waitcnt lgkmcnt(0)
    s_barrier
    ds_read_b128 v[48:51], v4 offset:24576
    ds_read_b64_tr_b16 v[56:57], v8 offset:24576
    ds_read_b64_tr_b16 v[58:59], v8 offset:25088
    v_mfma_f32_32x32x16_bf16 v[16:31], v[76:79], v[68:71], v[16:31]
    ds_read_b128 v[52:55], v4 offset:26624
    ds_read_b64_tr_b16 v[60:61], v8 offset:26624
    ds_read_b64_tr_b16 v[62:63], v8 offset:27136
    s_waitcnt lgkmcnt(3)
    v_mfma_f32_32x32x16_bf16 v[16:31], v[56:59], v[48:51], v[16:31]
    ds_read_b128 v[64:67], v4 offset:28672
    ds_read_b64_tr_b16 v[72:73], v8 offset:28672
    ds_read_b64_tr_b16 v[74:75], v8 offset:29184
    s_waitcnt lgkmcnt(3)
    v_mfma_f32_32x32x16_bf16 v[16:31], v[60:63], v[52:55], v[16:31]
    ds_read_b128 v[68:71], v4 offset:30720
    ds_read_b64_tr_b16 v[76:77], v8 offset:30720
    ds_read_b64_tr_b16 v[78:79], v8 offset:31232
    s_waitcnt lgkmcnt(3)
    v_mfma_f32_32x32x16_bf16 v[16:31], v[72:75], v[64:67], v[16:31]
    s_waitcnt lgkmcnt(0)
    s_barrier
    ds_read_b128 v[48:51], v4 offset:32768
    ds_read_b64_tr_b16 v[56:57], v8 offset:0
    ds_read_b64_tr_b16 v[58:59], v8 offset:512
    v_mfma_f32_32x32x16_bf16 v[16:31], v[76:79], v[68:71], v[16:31]
    ds_read_b128 v[52:55], v4 offset:34816
    ds_read_b64_tr_b16 v[60:61], v8 offset:2048
    ds_read_b64_tr_b16 v[62:63], v8 offset:2560
    s_waitcnt lgkmcnt(3)
    v_mfma_f32_32x32x16_bf16 v[16:31], v[56:59], v[48:51], v[16:31]
    ds_read_b128 v[64:67], v4 offset:36864
    ds_read_b64_tr_b16 v[72:73], v8 offset:4096
    ds_read_b64_tr_b16 v[74:75], v8 offset:4608
    s_waitcnt lgkmcnt(3)
    v_mfma_f32_32x32x16_bf16 v[16:31], v[60:63], v[52:55], v[16:31]
    ds_read_b128 v[68:71], v4 offset:38912
    ds_read_b64_tr_b16 v[76:77], v8 offset:6144
    ds_read_b64_tr_b16 v[78:79], v8 offset:6656
    s_waitcnt lgkmcnt(3)
    v_mfma_f32_32x32x16_bf16 v[16:31], v[72:75], v[64:67], v[16:31]
    s_waitcnt lgkmcnt(0)
    s_barrier
    ds_read_b128 v[48:51], v4 offset:40960
    ds_read_b64_tr_b16 v[56:57], v8 offset:8192
    ds_read_b64_tr_b16 v[58:59], v8 offset:8704
    v_mfma_f32_32x32x16_bf16 v[16:31], v[76:79], v[68:71], v[16:31]
    ds_read_b128 v[52:55], v4 offset:43008
    ds_read_b64_tr_b16 v[60:61], v8 offset:10240
    ds_read_b64_tr_b16 v[62:63], v8 offset:10752
    s_waitcnt lgkmcnt(3)
    v_mfma_f32_32x32x16_bf16 v[16:31], v[56:59], v[48:51], v[16:31]
    ds_read_b128 v[64:67], v4 offset:45056
    ds_read_b64_tr_b16 v[72:73], v8 offset:12288
    ds_read_b64_tr_b16 v[74:75], v8 offset:12800
    s_waitcnt lgkmcnt(3)
    v_mfma_f32_32x32x16_bf16 v[16:31], v[60:63], v[52:55], v[16:31]
    ds_read_b128 v[68:71], v4 offset:47104
    ds_read_b64_tr_b16 v[76:77], v8 offset:14336
    ds_read_b64_tr_b16 v[78:79], v8 offset:14848
    s_waitcnt lgkmcnt(3)
    v_mfma_f32_32x32x16_bf16 v[16:31], v[72:75], v[64:67], v[16:31]
    s_waitcnt lgkmcnt(0)
    s_barrier
    ds_read_b128 v[48:51], v4 offset:0
    ds_read_b64_tr_b16 v[56:57], v8 offset:16384
    ds_read_b64_tr_b16 v[58:59], v8 offset:16896
    v_mfma_f32_32x32x16_bf16 v[16:31], v[76:79], v[68:71], v[16:31]
    ds_read_b128 v[52:55], v4 offset:2048
    ds_read_b64_tr_b16 v[60:61], v8 offset:18432
    ds_read_b64_tr_b16 v[62:63], v8 offset:18944
    s_waitcnt lgkmcnt(3)
    v_mfma_f32_32x32x16_bf16 v[16:31], v[56:59], v[48:51], v[16:31]
    ds_read_b128 v[64:67], v4 offset:4096
    ds_read_b64_tr_b16 v[72:73], v8 offset:20480
    ds_read_b64_tr_b16 v[74:75], v8 offset:20992
    s_waitcnt lgkmcnt(3)
    v_mfma_f32_32x32x16_bf16 v[16:31], v[60:63], v[52:55], v[16:31]
    ds_read_b128 v[68:71], v4 offset:6144
    ds_read_b64_tr_b16 v[76:77], v8 offset:22528
    ds_read_b64_tr_b16 v[78:79], v8 offset:23040
    s_waitcnt lgkmcnt(3)
    v_mfma_f32_32x32x16_bf16 v[16:31], v[72:75], v[64:67], v[16:31]
    s_waitcnt lgkmcnt(0)
    s_barrier
    ds_read_b128 v[48:51], v4 offset:8192
    ds_read_b64_tr_b16 v[56:57], v8 offset:24576
    ds_read_b64_tr_b16 v[58:59], v8 offset:25088
    v_mfma_f32_32x32x16_bf16 v[16:31], v[76:79], v[68:71], v[16:31]
    ds_read_b128 v[52:55], v4 offset:10240
    ds_read_b64_tr_b16 v[60:61], v8 offset:26624
    ds_read_b64_tr_b16 v[62:63], v8 offset:27136
    s_waitcnt lgkmcnt(3)
    v_mfma_f32_32x32x16_bf16 v[16:31], v[56:59], v[48:51], v[16:31]
    ds_read_b128 v[64:67], v4 offset:12288
    ds_read_b64_tr_b16 v[72:73], v8 offset:28672
    ds_read_b64_tr_b16 v[74:75], v8 offset:29184
    s_waitcnt lgkmcnt(3)
    v_mfma_f32_32x32x16_bf16 v[16:31], v[60:63], v[52:55], v[16:31]
    ds_read_b128 v[68:71], v4 offset:14336
    ds_read_b64_tr_b16 v[76:77], v8 offset:30720
    ds_read_b64_tr_b16 v[78:79], v8 offset:31232
    s_waitcnt lgkmcnt(3)
    v_mfma_f32_32x32x16_bf16 v[16:31], v[72:75], v[64:67], v[16:31]
    s_waitcnt lgkmcnt(0)
    s_barrier
    ds_read_b128 v[48:51], v4 offset:16384
    ds_read_b64_tr_b16 v[56:57], v8 offset:0
    ds_read_b64_tr_b16 v[58:59], v8 offset:512
    v_mfma_f32_32x32x16_bf16 v[16:31], v[76:79], v[68:71], v[16:31]
    ds_read_b128 v[52:55], v4 offset:18432
    ds_read_b64_tr_b16 v[60:61], v8 offset:2048
    ds_read_b64_tr_b16 v[62:63], v8 offset:2560
    s_waitcnt vmcnt(0)
    s_nop 7
    v_cvt_pk_bf16_f32 v112, v16, v17
    v_cvt_pk_bf16_f32 v113, v18, v19
    v_cvt_pk_bf16_f32 v114, v20, v21
    v_cvt_pk_bf16_f32 v115, v22, v23
    v_lshlrev_b32 v16, 16, v112
    v_lshlrev_b32 v18, 16, v113
    v_lshlrev_b32 v20, 16, v114
    v_lshlrev_b32 v22, 16, v115
    v_and_b32 v17, 0xffff0000, v112
    v_and_b32 v19, 0xffff0000, v113
    v_and_b32 v21, 0xffff0000, v114
    v_and_b32 v23, 0xffff0000, v115
    v_lshlrev_b32 v116, 16, v96
    v_lshlrev_b32 v118, 16, v97
    v_lshlrev_b32 v120, 16, v98
    v_lshlrev_b32 v122, 16, v99
    v_and_b32 v117, 0xffff0000, v96
    v_and_b32 v119, 0xffff0000, v97
    v_and_b32 v121, 0xffff0000, v98
    v_and_b32 v123, 0xffff0000, v99
    v_add_f32 v16, v16, v116
    v_add_f32 v17, v17, v117
    v_add_f32 v18, v18, v118
    v_add_f32 v19, v19, v119
    v_add_f32 v20, v20, v120
    v_add_f32 v21, v21, v121
    v_add_f32 v22, v22, v122
    v_add_f32 v23, v23, v123
    v_cvt_pk_bf16_f32 v112, v16, v17
    v_cvt_pk_bf16_f32 v113, v18, v19
    v_cvt_pk_bf16_f32 v114, v20, v21
    v_cvt_pk_bf16_f32 v115, v22, v23
    v_lshlrev_b32 v16, 16, v112
    v_lshlrev_b32 v18, 16, v113
    v_lshlrev_b32 v20, 16, v114
    v_lshlrev_b32 v22, 16, v115
    v_and_b32 v17, 0xffff0000, v112
    v_and_b32 v19, 0xffff0000, v113
    v_and_b32 v21, 0xffff0000, v114
    v_and_b32 v23, 0xffff0000, v115
    v_lshlrev_b32 v116, 16, v104
    v_lshlrev_b32 v118, 16, v105
    v_lshlrev_b32 v120, 16, v106
    v_lshlrev_b32 v122, 16, v107
    v_and_b32 v117, 0xffff0000, v104
    v_and_b32 v119, 0xffff0000, v105
    v_and_b32 v121, 0xffff0000, v106
    v_and_b32 v123, 0xffff0000, v107
    v_add_f32 v16, v16, v116
    v_add_f32 v17, v17, v117
    v_add_f32 v18, v18, v118
    v_add_f32 v19, v19, v119
    v_add_f32 v20, v20, v120
    v_add_f32 v21, v21, v121
    v_add_f32 v22, v22, v122
    v_add_f32 v23, v23, v123
    v_cvt_pk_bf16_f32 v96, v16, v17
    v_cvt_pk_bf16_f32 v97, v18, v19
    v_cvt_pk_bf16_f32 v98, v20, v21
    v_cvt_pk_bf16_f32 v99, v22, v23
    buffer_store_dwordx4 v[96:99], v14, s[40:43], s58 offen offset:0
    v_cvt_pk_bf16_f32 v112, v24, v25
    v_cvt_pk_bf16_f32 v113, v26, v27
    v_cvt_pk_bf16_f32 v114, v28, v29
    v_cvt_pk_bf16_f32 v115, v30, v31
    v_lshlrev_b32 v24, 16, v112
    v_lshlrev_b32 v26, 16, v113
    v_lshlrev_b32 v28, 16, v114
    v_lshlrev_b32 v30, 16, v115
    v_and_b32 v25, 0xffff0000, v112
    v_and_b32 v27, 0xffff0000, v113
    v_and_b32 v29, 0xffff0000, v114
    v_and_b32 v31, 0xffff0000, v115
    v_lshlrev_b32 v116, 16, v100
    v_lshlrev_b32 v118, 16, v101
    v_lshlrev_b32 v120, 16, v102
    v_lshlrev_b32 v122, 16, v103
    v_and_b32 v117, 0xffff0000, v100
    v_and_b32 v119, 0xffff0000, v101
    v_and_b32 v121, 0xffff0000, v102
    v_and_b32 v123, 0xffff0000, v103
    v_add_f32 v24, v24, v116
    v_add_f32 v25, v25, v117
    v_add_f32 v26, v26, v118
    v_add_f32 v27, v27, v119
    v_add_f32 v28, v28, v120
    v_add_f32 v29, v29, v121
    v_add_f32 v30, v30, v122
    v_add_f32 v31, v31, v123
    v_cvt_pk_bf16_f32 v112, v24, v25
    v_cvt_pk_bf16_f32 v113, v26, v27
    v_cvt_pk_bf16_f32 v114, v28, v29
    v_cvt_pk_bf16_f32 v115, v30, v31
    v_lshlrev_b32 v24, 16, v112
    v_lshlrev_b32 v26, 16, v113
    v_lshlrev_b32 v28, 16, v114
    v_lshlrev_b32 v30, 16, v115
    v_and_b32 v25, 0xffff0000, v112
    v_and_b32 v27, 0xffff0000, v113
    v_and_b32 v29, 0xffff0000, v114
    v_and_b32 v31, 0xffff0000, v115
    v_lshlrev_b32 v116, 16, v108
    v_lshlrev_b32 v118, 16, v109
    v_lshlrev_b32 v120, 16, v110
    v_lshlrev_b32 v122, 16, v111
    v_and_b32 v117, 0xffff0000, v108
    v_and_b32 v119, 0xffff0000, v109
    v_and_b32 v121, 0xffff0000, v110
    v_and_b32 v123, 0xffff0000, v111
    v_add_f32 v24, v24, v116
    v_add_f32 v25, v25, v117
    v_add_f32 v26, v26, v118
    v_add_f32 v27, v27, v119
    v_add_f32 v28, v28, v120
    v_add_f32 v29, v29, v121
    v_add_f32 v30, v30, v122
    v_add_f32 v31, v31, v123
    v_cvt_pk_bf16_f32 v100, v24, v25
    v_cvt_pk_bf16_f32 v101, v26, v27
    v_cvt_pk_bf16_f32 v102, v28, v29
    v_cvt_pk_bf16_f32 v103, v30, v31
    buffer_store_dwordx4 v[100:103], v14, s[40:43], s58 offen offset:32
    s_endpgm
M_END:
    s_endpgm
.section .rodata,"a"
.p2align 6
.amdhsa_kernel parallel_sum__softmax_full_mha__mixer_gmlp__prompt_kernel
  .amdhsa_next_free_vgpr 128
  .amdhsa_next_free_sgpr 102
  .amdhsa_accum_offset 128
  .amdhsa_group_segment_fixed_size 0
  .amdhsa_kernarg_size 88
  .amdhsa_user_sgpr_count 2
  .amdhsa_user_sgpr_kernarg_segment_ptr 1
  .amdhsa_system_sgpr_workgroup_id_x 1
.end_amdhsa_kernel
```
